```python
import torch

def _softmax(x, axis=-1):
    return torch.softmax(x, dim=axis)
def _gelu(x):
    return torch.nn.functional.gelu(x, approximate="tanh")
def _silu(x):
    return torch.nn.functional.silu(x)
def _sigmoid(x):
    return torch.sigmoid(x)
def _layernorm(x, axis=-1, eps=1e-5):
    m = x.mean(dim=axis, keepdim=True)
    v = x.var(dim=axis, keepdim=True, unbiased=False)
    return (x - m) / torch.sqrt(v + eps)
def _scatter_add(tgt, idx, src, axis=0):
    return tgt.clone().index_add_(axis, idx, src)
def _segment_sum(src, seg, n):
    out = torch.zeros((n,) + src.shape[1:], dtype=src.dtype)
    return out.index_add_(0, seg, src)
def _pad(x, pw):
    flat = tuple(v for pair in reversed(pw) for v in pair)
    return torch.nn.functional.pad(x, flat)

kernel_name = 'gated_mix__linear_attn_block__grouped_kv_mqa__prompt'

def setup_inputs():

    _w = (lambda a: (lambda t: t.to(torch.bfloat16) if t.is_floating_point() else t)(torch.as_tensor(a)))
    def _A_setup():
        B, S, D = 1, 2048, 512
        return {
            "x": _w((lambda *s: torch.randn(*s, dtype=torch.bfloat16) * 0.05)(B, S, D)),
            "wqkv": _w((lambda *s: torch.randn(*s, dtype=torch.bfloat16) * 1.6)(D, 3 * D)),
            "wo": _w((lambda *s: torch.randn(*s, dtype=torch.bfloat16) * 0.05)(D, D)),
        }
    _A_in = _A_setup()

    def _B_setup():
        B, S, D, H = 1, 2048, 512, 32
        Dh = D // H
        return {
            "x": _w((lambda *s: torch.randn(*s, dtype=torch.bfloat16) * 0.05)(B, S, D)),
            "wq": _w((lambda *s: torch.randn(*s, dtype=torch.bfloat16) * 1.6)(D, H * Dh)),
            "wk": _w((lambda *s: torch.randn(*s, dtype=torch.bfloat16) * 1.6)(D, Dh)),
            "wv": _w((lambda *s: torch.randn(*s, dtype=torch.bfloat16) * 0.05)(D, Dh)),
            "wo": _w((lambda *s: torch.randn(*s, dtype=torch.bfloat16) * 0.05)(H * Dh, D)),
        }
    _B_in = _B_setup()

    return {
        "A_x": _A_in["x"],
        "A_wqkv": _A_in["wqkv"],
        "A_wo": _A_in["wo"],
        "B_x": _B_in["x"],
        "B_wq": _B_in["wq"],
        "B_wk": _B_in["wk"],
        "B_wv": _B_in["wv"],
        "B_wo": _B_in["wo"],
        "gate_w": _w((lambda *s: torch.randn(*s, dtype=torch.bfloat16) * 0.05)(512) * 16.0),
    }

def reference(A_x, A_wqkv, A_wo, B_x, B_wq, B_wk, B_wv, B_wo, gate_w):
    def _A_ref(x, wqkv, wo):
        B, S, D = x.shape
        H = 32; Dh = D // H
        qkv = (lambda x, *d: x.permute(*d))((x @ wqkv).reshape(B, S, 3, H, Dh), 2, 0, 3, 1, 4)
        q, k, v = qkv[0], qkv[1], qkv[2]
        phi = lambda t: torch.where(t > 0, t + 1, torch.exp(t)) + 1e-6
        pq, pk = phi(q), phi(k)
        kv = torch.einsum("bhsd,bhse->bhde", pk, v)
        z = torch.einsum("bhsd->bhd", pk)
        num = torch.einsum("bhqd,bhde->bhqe", pq, kv)
        den = torch.einsum("bhqd,bhd->bhq", pq, z)[..., None] + 1e-6
        o = num / den
        return (lambda x, *d: x.permute(*d))(o, 0, 2, 1, 3).reshape(B, S, D) @ wo

    def _B_ref(x, wq, wk, wv, wo):
        B, S, D = x.shape
        H = 32
        Dh = D // H
        q = (lambda x, *d: x.permute(*d))((x @ wq).reshape(B, S, H, Dh), 0, 2, 1, 3)
        k = x @ wk
        v = x @ wv
        scores = torch.einsum("bhqd,bkd->bhqk", q, k) * (Dh ** -0.5)
        p = _softmax(scores, axis=-1)
        o = torch.einsum("bhqk,bkd->bhqd", p, v)
        return (lambda x, *d: x.permute(*d))(o, 0, 2, 1, 3).reshape(B, S, H * Dh) @ wo

    x = A_x
    g = _sigmoid((x * gate_w).sum(-1, keepdims=True))
    a = _A_ref(x, A_wqkv, A_wo)
    b = _B_ref(x, B_wq, B_wk, B_wv, B_wo)
    return g * a + (1 - g) * b
```

```asm
; @launch grid=(256,1,1) block=(768,1,1) lds=163840
.amdgcn_target "amdgcn-amd-amdhsa--gfx950"
.text
.globl gated_mix__linear_attn_block__grouped_kv_mqa__prompt_kernel
.p2align 8
.type gated_mix__linear_attn_block__grouped_kv_mqa__prompt_kernel,@function
gated_mix__linear_attn_block__grouped_kv_mqa__prompt_kernel:
    s_cmp_ge_u32 s2, 256
    s_cbranch_scc1 L_end
    s_load_dwordx16 s[76:91], s[0:1], 0
    s_load_dwordx8 s[92:99], s[0:1], 64
    v_and_b32 v1, 63, v0
    v_lshrrev_b32 v2, 6, v0
    s_and_b32 s53, s2, 7
    v_readfirstlane_b32 s48, v2
    s_lshl_b32 s53, s53, 2
    s_bfe_u32 s54, s2, 0x20003
    s_add_u32 s49, s53, s54
    s_sub_u32 s48, s48, 4
    s_cselect_b32 s54, 12, 0
    s_add_u32 s48, s48, s54
    s_lshr_b32 s50, s2, 5
    s_lshr_b32 s22, s50, 1
    s_xor_b32 s3, s50, 1
    s_xor_b32 s23, s50, 2
    v_lshrrev_b32 v2, 4, v1
    v_xor_b32 v2, v2, v1
    v_and_b32 v2, 3, v2
    v_lshlrev_b32 v2, 4, v2
    v_lshrrev_b32 v3, 2, v1
    v_lshl_add_u32 v6, v3, 10, v2
    v_lshlrev_b32 v11, 4, v1
    v_lshlrev_b32 v156, 2, v1
    s_mov_b32 s10, 0x200000
    s_mov_b32 s11, 0x20000
    s_and_b32 s69, s2, 7
    s_and_b32 s54, s50, 0
    s_xor_b32 s69, s69, s54
    s_lshl_b32 s54, s49, 1
    s_and_b32 s54, s54, 0
    s_xor_b32 s69, s69, s54
    s_lshl_b32 s53, s49, 16
    s_lshl_b32 s54, s69, 7
    s_or_b32 s53, s53, s54
    s_cmp_eq_u32 s48, 8
    s_cbranch_scc1 L_a0
    s_cmp_eq_u32 s48, 9
    s_cbranch_scc1 L_a1
    s_cmp_ge_u32 s48, 10
    s_cbranch_scc1 L_a23
    s_and_b32 s51, s48, 1
    s_lshr_b32 s52, s48, 1
    s_getpc_b64 s[40:41]
L_pc:
    s_lshr_b32 s55, s2, 3
    s_lshl_b32 s55, s55, 10
    s_cmp_eq_u32 s48, 0
    s_cselect_b64 s[24:25], 0xff, 1
    v_lshlrev_b32 v4, 7, v1
    v_add_u32 v4, s55, v4
    v_min_u32 v4, L_codeend - L_pc - 4, v4
    s_mov_b64 exec, s[24:25]
    global_load_dword v157, v4, s[40:41]
    s_mov_b64 exec, -1
    s_and_b32 s54, s48, 3
    s_lshr_b32 s55, s48, 2
    s_lshl_b32 s56, s54, 14
    s_add_u32 s57, s53, s56
    s_lshl_b32 s56, s55, 7
    s_xor_b32 s57, s57, s56
    s_lshl_b32 s58, s54, 10
    s_lshl_b32 s56, s55, 13
    s_add_u32 s58, s58, s56
    s_cmp_eq_u32 s54, s22
    s_cselect_b64 s[24:25], 1, -1
    v_lshrrev_b32 v2, 3, v1
    v_and_b32 v5, 7, v1
    v_lshlrev_b32 v5, 7, v5
    v_lshl_add_u32 v4, v2, 10, v5
    v_mul_u32_u24 v2, 3072, v2
    v_add_u32 v2, v2, v5
    s_xor_b32 s55, s48, s69
    s_lshl_b32 s55, s55, 5
    s_lshr_b32 s56, s2, 3
    s_add_u32 s55, s55, s56
    s_lshl_b32 s59, s55, 11
    s_mul_i32 s60, s55, 6144
    s_lshl_b32 s56, s50, 13
    s_lshl_b32 s7, s48, 10
    s_add_u32 s56, s56, s7
    s_lshl_b32 s7, s49, 16
    s_add_u32 s56, s56, s7
    s_waitcnt lgkmcnt(0)
    s_mov_b32 s8, s76
    s_mov_b32 s9, s77
    s_load_dword s4, s[98:99], 0
    s_xor_b32 s54, s57, 0
    s_add_u32 m0, s58, 65536
    s_mov_b64 exec, s[24:25]
    buffer_load_dwordx4 v6, s[8:11], s54 offen lds
    s_add_u32 m0, s58, 69568
    s_nop 0
    buffer_load_dwordx4 v6, s[8:11], s54 offen offset:64 lds
    s_mov_b64 exec, -1
    s_mov_b32 s44, s98
    s_mov_b32 s45, s99
    s_mov_b32 s46, 0x1000000
    s_mov_b32 s47, 0x20000
    s_mov_b32 s36, s94
    s_mov_b32 s37, s95
    s_mov_b32 s38, 0x200000
    s_mov_b32 s39, 0x20000
    s_and_b32 s5, s2, 7
    s_lshl_b32 s5, s5, 2
    s_bfe_u32 s54, s2, 0x20003
    s_add_u32 s5, s5, s54
    s_lshr_b32 s6, s2, 5
    s_xor_b32 s54, s57, 256
    s_add_u32 m0, s58, 81920
    s_mov_b64 exec, s[24:25]
    buffer_load_dwordx4 v6, s[8:11], s54 offen lds
    s_add_u32 m0, s58, 85952
    s_nop 0
    buffer_load_dwordx4 v6, s[8:11], s54 offen offset:64 lds
    s_mov_b64 exec, -1
    s_mov_b32 s64, 0xffff
    s_mov_b32 s65, 0xffff
    s_mov_b32 s70, 0x3fb8aa3b
    s_mov_b32 s71, 0x3fb8aa3b
    s_mov_b32 s20, 0x358637bd
    s_mov_b32 s21, 0x3f803f80
    s_lshl_b32 s63, s50, 2
    s_add_u32 s63, s63, s52
    s_lshl_b32 s26, s3, 2
    s_add_u32 s26, s26, s52
    s_lshl_b32 s66, s49, 1
    s_add_u32 s66, s66, s51
    s_lshl_b32 s67, s5, 1
    s_add_u32 s67, s67, s51
    s_mov_b32 s72, 0x3eb8aa3b
    s_mov_b32 s73, 0x3eb8aa3b
    v_and_b32 v2, 31, v1
    v_lshrrev_b32 v3, 5, v1
    v_bfe_u32 v4, v1, 2, 2
    v_xor_b32 v4, v4, v3
    v_lshlrev_b32 v4, 4, v4
    v_lshl_add_u32 v5, v2, 6, v4
    s_lshl_b32 s53, s51, 11
    s_add_u32 s53, s53, 65536
    v_add_u32 v8, s53, v5
    v_xor_b32 v9, 32, v8
    v_bfe_u32 v2, v1, 4, 1
    v_bfe_u32 v4, v1, 3, 2
    v_xor_b32 v4, s52, v4
    v_lshlrev_b32 v4, 5, v4
    v_lshl_add_u32 v4, v2, 13, v4
    v_lshl_add_u32 v4, v3, 10, v4
    v_bfe_u32 v2, v1, 2, 2
    v_lshl_add_u32 v4, v2, 7, v4
    v_and_b32 v2, 3, v1
    v_lshl_add_u32 v10, v2, 3, v4
    v_add_u32 v161, 131072, v10
    v_mov_b32 v24, 0
    v_mov_b32 v32, s20
    v_mov_b32 v25, 0
    v_mov_b32 v33, s20
    v_mov_b32 v26, 0
    v_mov_b32 v34, s20
    v_mov_b32 v27, 0
    v_mov_b32 v35, s20
    v_mov_b32 v28, 0
    v_mov_b32 v36, s20
    v_mov_b32 v29, 0
    v_mov_b32 v37, s20
    v_mov_b32 v30, 0
    v_mov_b32 v38, s20
    v_mov_b32 v31, 0
    v_mov_b32 v39, s20
    v_mov_b32 v2, s21
    s_mov_b32 s40, 0x110000
    s_mov_b32 s41, 0x110000
    v_cndmask_b32 v2, 0, v2, s[40:41]
    v_mov_b32 v104, 0
    v_mov_b32 v140, v2
    v_mov_b32 v105, 0
    v_mov_b32 v141, v2
    v_mov_b32 v106, 0
    v_mov_b32 v142, v2
    v_mov_b32 v107, 0
    v_mov_b32 v143, v2
    v_mov_b32 v108, 0
    v_mov_b32 v144, v2
    v_mov_b32 v109, 0
    v_mov_b32 v145, v2
    v_mov_b32 v110, 0
    v_mov_b32 v146, v2
    v_mov_b32 v111, 0
    v_mov_b32 v147, v2
    v_mov_b32 v112, 0
    v_mov_b32 v148, v2
    v_mov_b32 v113, 0
    v_mov_b32 v149, v2
    v_mov_b32 v114, 0
    v_mov_b32 v150, v2
    v_mov_b32 v115, 0
    v_mov_b32 v151, v2
    v_mov_b32 v116, 0
    v_mov_b32 v152, v2
    v_mov_b32 v117, 0
    v_mov_b32 v153, v2
    v_mov_b32 v118, 0
    v_mov_b32 v154, v2
    v_mov_b32 v119, 0
    v_mov_b32 v155, v2
    v_mov_b32 v13, 0xdddd
    v_mov_b32 v14, v11
    v_and_b32 v5, 15, v1
    v_lshlrev_b32 v5, 4, v5
    v_lshl_add_u32 v15, v3, 8, v5
    s_lshl_b32 s7, s66, 6
    s_add_u32 s7, s7, s63
    s_lshl_b32 s7, s7, 10
    s_add_u32 s7, s7, 2129920
    s_lshl_b32 s27, s66, 6
    s_add_u32 s27, s27, s26
    s_lshl_b32 s27, s27, 10
    s_add_u32 s27, s27, 2097152
    v_and_b32 v2, 0x3c, v156
    v_bfe_u32 v3, v1, 4, 1
    v_lshl_add_u32 v7, v3, 7, v2
    s_lshl_b32 s28, s66, 8
    s_add_u32 s28, s28, 81920
    v_mov_b32 v162, -1
    v_mov_b32 v163, -1
    v_mov_b32 v164, -1
    v_mov_b32 v165, -1
    s_lshl_b32 s29, s66, 5
    s_add_u32 s29, s29, s63
    s_lshl_b32 s29, s29, 2
    s_add_u32 s29, s29, 16384
    v_lshrrev_b32 v2, 5, v1
    v_lshlrev_b32 v2, 9, v2
    v_bfe_u32 v3, v1, 2, 2
    v_lshl_add_u32 v2, v3, 7, v2
    v_bfe_u32 v3, v1, 3, 1
    v_lshl_add_u32 v2, v3, 6, v2
    v_bfe_u32 v3, v1, 4, 1
    v_lshl_add_u32 v2, v3, 5, v2
    v_and_b32 v3, 3, v1
    v_lshl_add_u32 v2, v3, 3, v2
    s_lshl_b32 s53, s52, 14
    v_add_u32 v159, s53, v2
    v_xor_b32 v160, 64, v159
    s_lshl_b32 s57, s67, 3
    s_add_u32 s57, s57, s52
    s_lshl_b32 s57, s57, 13
    s_add_u32 s57, s57, 2097152
    s_add_u32 s58, s57, 4096
    s_lshl_b32 s59, s67, 4
    s_add_u32 s59, s59, s52
    s_lshl_b32 s59, s59, 12
    s_add_u32 s59, s59, 2129920
    s_add_u32 s60, s59, 16384
    s_and_b32 s54, s26, 1
    v_lshrrev_b32 v3, 5, v1
    s_lshl_b32 s55, s54, 1
    s_add_u32 s55, s55, 64
    v_add_u32 v3, s55, v3
    v_and_b32 v2, 0x2f, v1
    s_lshl_b32 s55, s54, 4
    v_add_u32 v2, s55, v2
    v_cndmask_b32 v2, v2, v3, s[64:65]
    v_lshlrev_b32 v166, 2, v2
    s_lshr_b32 s31, s26, 1
    s_lshl_b32 s31, s31, 12
    s_add_u32 s31, s31, 262144
    s_lshl_b32 s30, s67, 7
    s_add_u32 s30, s30, 16384
    s_waitcnt lgkmcnt(0)
    s_mul_i32 s4, s4, 0x9e3779b1
    s_add_u32 s4, s4, 0x7f4a7c15
    v_mov_b32 v158, s4
    s_waitcnt vmcnt(2) lgkmcnt(0)
    s_barrier
    ds_read_b128 v[40:43], v8 offset:0
    ds_read_b64_tr_b16 v[56:57], v10 offset:16384
    ds_read_b64_tr_b16 v[58:59], v10 offset:16896
    ds_read_b128 v[44:47], v9 offset:0
    ds_read_b64_tr_b16 v[60:61], v10 offset:18432
    ds_read_b64_tr_b16 v[62:63], v10 offset:18944
    ds_read_b128 v[48:51], v8 offset:4096
    ds_read_b64_tr_b16 v[64:65], v10 offset:20480
    ds_read_b64_tr_b16 v[66:67], v10 offset:20992
    ds_read_b128 v[52:55], v9 offset:4096
    ds_read_b64_tr_b16 v[68:69], v10 offset:22528
    ds_read_b64_tr_b16 v[70:71], v10 offset:23040
    s_waitcnt lgkmcnt(0)
    s_barrier
    v_mfma_f32_32x32x16_bf16 v[24:39], v[56:59], v[40:43], v[24:39]
    ds_read_b128 v[72:75], v8 offset:8192
    ds_read_b64_tr_b16 v[88:89], v10 offset:32768
    ds_read_b64_tr_b16 v[90:91], v10 offset:33280
    ds_read_b128 v[76:79], v9 offset:8192
    v_mfma_f32_32x32x16_bf16 v[24:39], v[60:63], v[44:47], v[24:39]
    ds_read_b64_tr_b16 v[92:93], v10 offset:34816
    ds_read_b64_tr_b16 v[94:95], v10 offset:35328
    ds_read_b128 v[80:83], v8 offset:12288
    ds_read_b64_tr_b16 v[96:97], v10 offset:36864
    v_mfma_f32_32x32x16_bf16 v[24:39], v[64:67], v[48:51], v[24:39]
    ds_read_b64_tr_b16 v[98:99], v10 offset:37376
    ds_read_b128 v[84:87], v9 offset:12288
    ds_read_b64_tr_b16 v[100:101], v10 offset:38912
    ds_read_b64_tr_b16 v[102:103], v10 offset:39424
    v_mfma_f32_32x32x16_bf16 v[24:39], v[68:71], v[52:55], v[24:39]
    s_waitcnt vmcnt(0) lgkmcnt(0)
    s_barrier
    v_mfma_f32_32x32x16_bf16 v[24:39], v[88:91], v[72:75], v[24:39]
    ds_read_b128 v[40:43], v8 offset:16384
    ds_read_b64_tr_b16 v[56:57], v10 offset:49152
    ds_read_b64_tr_b16 v[58:59], v10 offset:49664
    ds_read_b128 v[44:47], v9 offset:16384
    v_mfma_f32_32x32x16_bf16 v[24:39], v[92:95], v[76:79], v[24:39]
    ds_read_b64_tr_b16 v[60:61], v10 offset:51200
    ds_read_b64_tr_b16 v[62:63], v10 offset:51712
    ds_read_b128 v[48:51], v8 offset:20480
    ds_read_b64_tr_b16 v[64:65], v10 offset:53248
    v_mfma_f32_32x32x16_bf16 v[24:39], v[96:99], v[80:83], v[24:39]
    ds_read_b64_tr_b16 v[66:67], v10 offset:53760
    ds_read_b128 v[52:55], v9 offset:20480
    ds_read_b64_tr_b16 v[68:69], v10 offset:55296
    ds_read_b64_tr_b16 v[70:71], v10 offset:55808
    v_mfma_f32_32x32x16_bf16 v[24:39], v[100:103], v[84:87], v[24:39]
    s_waitcnt lgkmcnt(0)
    s_barrier
    v_mfma_f32_32x32x16_bf16 v[24:39], v[56:59], v[40:43], v[24:39]
    ds_read_b128 v[72:75], v8 offset:24576
    ds_read_b64_tr_b16 v[88:89], v161 offset:0
    ds_read_b64_tr_b16 v[90:91], v161 offset:512
    ds_read_b128 v[76:79], v9 offset:24576
    v_mfma_f32_32x32x16_bf16 v[24:39], v[60:63], v[44:47], v[24:39]
    ds_read_b64_tr_b16 v[92:93], v161 offset:2048
    ds_read_b64_tr_b16 v[94:95], v161 offset:2560
    ds_read_b128 v[80:83], v8 offset:28672
    ds_read_b64_tr_b16 v[96:97], v161 offset:4096
    v_mfma_f32_32x32x16_bf16 v[24:39], v[64:67], v[48:51], v[24:39]
    ds_read_b64_tr_b16 v[98:99], v161 offset:4608
    ds_read_b128 v[84:87], v9 offset:28672
    ds_read_b64_tr_b16 v[100:101], v161 offset:6144
    ds_read_b64_tr_b16 v[102:103], v161 offset:6656
    v_mfma_f32_32x32x16_bf16 v[24:39], v[68:71], v[52:55], v[24:39]
    s_waitcnt lgkmcnt(0)
    s_barrier
    v_mfma_f32_32x32x16_bf16 v[24:39], v[88:91], v[72:75], v[24:39]
    ds_read_b128 v[40:43], v8 offset:32768
    ds_read_b64_tr_b16 v[56:57], v10 offset:16384
    ds_read_b64_tr_b16 v[58:59], v10 offset:16896
    ds_read_b128 v[44:47], v9 offset:32768
    v_mfma_f32_32x32x16_bf16 v[24:39], v[92:95], v[76:79], v[24:39]
    ds_read_b64_tr_b16 v[60:61], v10 offset:18432
    ds_read_b64_tr_b16 v[62:63], v10 offset:18944
    ds_read_b128 v[48:51], v8 offset:36864
    ds_read_b64_tr_b16 v[64:65], v10 offset:20480
    v_mfma_f32_32x32x16_bf16 v[24:39], v[96:99], v[80:83], v[24:39]
    ds_read_b64_tr_b16 v[66:67], v10 offset:20992
    ds_read_b128 v[52:55], v9 offset:36864
    ds_read_b64_tr_b16 v[68:69], v10 offset:22528
    ds_read_b64_tr_b16 v[70:71], v10 offset:23040
    v_mfma_f32_32x32x16_bf16 v[24:39], v[100:103], v[84:87], v[24:39]
    s_waitcnt lgkmcnt(0)
    s_barrier
    v_mfma_f32_32x32x16_bf16 v[24:39], v[56:59], v[40:43], v[24:39]
    ds_read_b128 v[72:75], v8 offset:40960
    ds_read_b64_tr_b16 v[88:89], v10 offset:32768
    ds_read_b64_tr_b16 v[90:91], v10 offset:33280
    ds_read_b128 v[76:79], v9 offset:40960
    v_mfma_f32_32x32x16_bf16 v[24:39], v[60:63], v[44:47], v[24:39]
    ds_read_b64_tr_b16 v[92:93], v10 offset:34816
    ds_read_b64_tr_b16 v[94:95], v10 offset:35328
    ds_read_b128 v[80:83], v8 offset:45056
    ds_read_b64_tr_b16 v[96:97], v10 offset:36864
    v_mfma_f32_32x32x16_bf16 v[24:39], v[64:67], v[48:51], v[24:39]
    ds_read_b64_tr_b16 v[98:99], v10 offset:37376
    ds_read_b128 v[84:87], v9 offset:45056
    ds_read_b64_tr_b16 v[100:101], v10 offset:38912
    ds_read_b64_tr_b16 v[102:103], v10 offset:39424
    v_mfma_f32_32x32x16_bf16 v[24:39], v[68:71], v[52:55], v[24:39]
    s_waitcnt lgkmcnt(0)
    s_barrier
    v_mfma_f32_32x32x16_bf16 v[24:39], v[88:91], v[72:75], v[24:39]
    ds_read_b128 v[40:43], v8 offset:49152
    ds_read_b64_tr_b16 v[56:57], v10 offset:49152
    ds_read_b64_tr_b16 v[58:59], v10 offset:49664
    ds_read_b128 v[44:47], v9 offset:49152
    v_mfma_f32_32x32x16_bf16 v[24:39], v[92:95], v[76:79], v[24:39]
    ds_read_b64_tr_b16 v[60:61], v10 offset:51200
    ds_read_b64_tr_b16 v[62:63], v10 offset:51712
    ds_read_b128 v[48:51], v8 offset:53248
    ds_read_b64_tr_b16 v[64:65], v10 offset:53248
    v_mfma_f32_32x32x16_bf16 v[24:39], v[96:99], v[80:83], v[24:39]
    ds_read_b64_tr_b16 v[66:67], v10 offset:53760
    ds_read_b128 v[52:55], v9 offset:53248
    ds_read_b64_tr_b16 v[68:69], v10 offset:55296
    ds_read_b64_tr_b16 v[70:71], v10 offset:55808
    v_mfma_f32_32x32x16_bf16 v[24:39], v[100:103], v[84:87], v[24:39]
    s_waitcnt lgkmcnt(0)
    s_barrier
    v_mfma_f32_32x32x16_bf16 v[24:39], v[56:59], v[40:43], v[24:39]
    ds_read_b128 v[72:75], v8 offset:57344
    ds_read_b64_tr_b16 v[88:89], v161 offset:0
    ds_read_b64_tr_b16 v[90:91], v161 offset:512
    ds_read_b128 v[76:79], v9 offset:57344
    v_mfma_f32_32x32x16_bf16 v[24:39], v[60:63], v[44:47], v[24:39]
    ds_read_b64_tr_b16 v[92:93], v161 offset:2048
    ds_read_b64_tr_b16 v[94:95], v161 offset:2560
    ds_read_b128 v[80:83], v8 offset:61440
    ds_read_b64_tr_b16 v[96:97], v161 offset:4096
    v_mfma_f32_32x32x16_bf16 v[24:39], v[64:67], v[48:51], v[24:39]
    ds_read_b64_tr_b16 v[98:99], v161 offset:4608
    ds_read_b128 v[84:87], v9 offset:61440
    ds_read_b64_tr_b16 v[100:101], v161 offset:6144
    ds_read_b64_tr_b16 v[102:103], v161 offset:6656
    v_mfma_f32_32x32x16_bf16 v[24:39], v[68:71], v[52:55], v[24:39]
    s_waitcnt lgkmcnt(9)
    v_mfma_f32_32x32x16_bf16 v[24:39], v[88:91], v[72:75], v[24:39]
    s_waitcnt lgkmcnt(6)
    v_mfma_f32_32x32x16_bf16 v[24:39], v[92:95], v[76:79], v[24:39]
    s_waitcnt lgkmcnt(3)
    v_mfma_f32_32x32x16_bf16 v[24:39], v[96:99], v[80:83], v[24:39]
    s_waitcnt lgkmcnt(0)
    v_mfma_f32_32x32x16_bf16 v[24:39], v[100:103], v[84:87], v[24:39]
    s_mov_b32 s61, 0
    s_nop 10
    v_pk_mul_f32 v[24:25], s[72:73], v[24:25]
    v_pk_mul_f32 v[26:27], s[72:73], v[26:27]
    v_pk_mul_f32 v[28:29], s[72:73], v[28:29]
    v_pk_mul_f32 v[30:31], s[72:73], v[30:31]
    v_cvt_pk_bf16_f32 v16, v24, v25
    v_cvt_pk_bf16_f32 v17, v26, v27
    v_cvt_pk_bf16_f32 v18, v28, v29
    v_cvt_pk_bf16_f32 v19, v30, v31
    v_pk_mul_f32 v[40:41], s[70:71], v[32:33]
    v_pk_mul_f32 v[42:43], s[70:71], v[34:35]
    v_pk_mul_f32 v[44:45], s[70:71], v[36:37]
    v_pk_mul_f32 v[46:47], s[70:71], v[38:39]
    v_exp_f32 v40, v40 clamp
    v_exp_f32 v41, v41 clamp
    v_exp_f32 v42, v42 clamp
    v_exp_f32 v43, v43 clamp
    v_exp_f32 v44, v44 clamp
    v_exp_f32 v45, v45 clamp
    v_exp_f32 v46, v46 clamp
    v_exp_f32 v47, v47 clamp
    v_max_f32 v32, s20, v32
    v_max_f32 v33, s20, v33
    v_max_f32 v34, s20, v34
    v_max_f32 v35, s20, v35
    v_max_f32 v36, s20, v36
    v_max_f32 v37, s20, v37
    v_max_f32 v38, s20, v38
    v_max_f32 v39, s20, v39
    v_pk_add_f32 v[32:33], v[32:33], v[40:41]
    v_pk_add_f32 v[34:35], v[34:35], v[42:43]
    v_pk_add_f32 v[36:37], v[36:37], v[44:45]
    v_pk_add_f32 v[38:39], v[38:39], v[46:47]
    v_cvt_pk_bf16_f32 v20, v32, v33
    v_cvt_pk_bf16_f32 v21, v34, v35
    v_cvt_pk_bf16_f32 v22, v36, v37
    v_cvt_pk_bf16_f32 v23, v38, v39
    s_barrier
    s_setprio 3
    ds_read_b128 v[136:139], v14
    s_mov_b64 exec, s[64:65]
    ds_read_b128 v[140:143], v15 offset:1024
    ds_read_b128 v[144:147], v15 offset:1536
    ds_read_b128 v[148:151], v15 offset:3072
    ds_read_b128 v[152:155], v15 offset:3584
    s_mov_b64 exec, -1
    s_waitcnt lgkmcnt(4)
    v_mfma_f32_32x32x16_bf16 v[24:39], v[136:139], v[16:19], 0
    ds_read_b128 v[136:139], v14 offset:2048
    s_nop 10
    v_max3_f32 v2, v24, v25, v26
    v_max3_f32 v3, v27, v28, v29
    v_max3_f32 v4, v30, v31, v32
    v_max3_f32 v5, v33, v34, v35
    v_max3_f32 v2, v2, v36, v37
    v_max3_f32 v3, v3, v38, v39
    v_max3_f32 v2, v2, v3, v4
    v_max_f32 v2, v2, v5
    v_mov_b32 v3, v2
    s_nop 1
    v_permlane32_swap_b32 v2, v3
    s_nop 1
    v_max_f32 v2, v2, v3
    v_sub_f32 v4, 0, v2
    v_sub_f32 v5, 0, v2
    v_pk_add_f32 v[24:25], v[24:25], v[4:5]
    v_pk_add_f32 v[26:27], v[26:27], v[4:5]
    v_pk_add_f32 v[28:29], v[28:29], v[4:5]
    v_pk_add_f32 v[30:31], v[30:31], v[4:5]
    v_pk_add_f32 v[32:33], v[32:33], v[4:5]
    v_pk_add_f32 v[34:35], v[34:35], v[4:5]
    v_pk_add_f32 v[36:37], v[36:37], v[4:5]
    v_pk_add_f32 v[38:39], v[38:39], v[4:5]
    v_pk_mov_b32 v[120:121], v[4:5], v[4:5] op_sel:[0,1]
    v_pk_mov_b32 v[122:123], v[4:5], v[4:5] op_sel:[0,1]
    v_pk_mov_b32 v[124:125], v[4:5], v[4:5] op_sel:[0,1]
    v_pk_mov_b32 v[126:127], v[4:5], v[4:5] op_sel:[0,1]
    v_pk_mov_b32 v[128:129], v[4:5], v[4:5] op_sel:[0,1]
    v_pk_mov_b32 v[130:131], v[4:5], v[4:5] op_sel:[0,1]
    v_pk_mov_b32 v[132:133], v[4:5], v[4:5] op_sel:[0,1]
    v_pk_mov_b32 v[134:135], v[4:5], v[4:5] op_sel:[0,1]
    v_exp_f32 v24, v24
    v_exp_f32 v25, v25
    s_waitcnt lgkmcnt(0)
    s_mov_b32 s62, 0
    s_setprio 2
    v_exp_f32 v26, v26
    v_exp_f32 v27, v27
    v_exp_f32 v28, v28
    v_exp_f32 v29, v29
    s_waitcnt lgkmcnt(2)
    v_mfma_f32_32x32x16_bf16 v[40:55], v[136:139], v[16:19], v[120:135]
    ds_read_b128 v[136:139], v14 offset:4096
    v_exp_f32 v30, v30
    v_exp_f32 v31, v31
    v_exp_f32 v32, v32
    v_exp_f32 v33, v33
    v_exp_f32 v34, v34
    v_smfmac_f32_32x32x32_bf16 v[104:119], v[140:143], v[24:31], v13
    v_exp_f32 v35, v35
    v_exp_f32 v36, v36
    v_exp_f32 v37, v37
    v_exp_f32 v38, v38
    v_exp_f32 v39, v39
    v_exp_f32 v40, v40
    v_exp_f32 v41, v41
    v_smfmac_f32_32x32x32_bf16 v[104:119], v[144:147], v[32:39], v13
    s_mov_b64 exec, s[64:65]
    ds_read_b128 v[140:143], v15 offset:5120
    ds_read_b128 v[144:147], v15 offset:5632
    s_mov_b64 exec, -1
    v_exp_f32 v42, v42
    v_exp_f32 v43, v43
    v_exp_f32 v44, v44
    v_exp_f32 v45, v45
    s_waitcnt lgkmcnt(2)
    v_mfma_f32_32x32x16_bf16 v[24:39], v[136:139], v[16:19], v[120:135]
    ds_read_b128 v[136:139], v14 offset:6144
    v_exp_f32 v46, v46
    v_exp_f32 v47, v47
    v_exp_f32 v48, v48
    v_exp_f32 v49, v49
    v_exp_f32 v50, v50
    v_smfmac_f32_32x32x32_bf16 v[104:119], v[148:151], v[40:47], v13
    v_exp_f32 v51, v51
    v_exp_f32 v52, v52
    v_exp_f32 v53, v53
    v_exp_f32 v54, v54
    v_exp_f32 v55, v55
    v_exp_f32 v24, v24
    v_exp_f32 v25, v25
    v_smfmac_f32_32x32x32_bf16 v[104:119], v[152:155], v[48:55], v13
    s_mov_b64 exec, s[64:65]
    ds_read_b128 v[148:151], v15 offset:7168
    ds_read_b128 v[152:155], v15 offset:7680
    s_mov_b64 exec, -1
    v_exp_f32 v26, v26
    v_exp_f32 v27, v27
    v_exp_f32 v28, v28
    v_exp_f32 v29, v29
    s_waitcnt lgkmcnt(2)
    v_mfma_f32_32x32x16_bf16 v[40:55], v[136:139], v[16:19], v[120:135]
    ds_read_b128 v[136:139], v14 offset:8192
    v_exp_f32 v30, v30
    v_exp_f32 v31, v31
    v_exp_f32 v32, v32
    v_exp_f32 v33, v33
    v_exp_f32 v34, v34
    v_smfmac_f32_32x32x32_bf16 v[104:119], v[140:143], v[24:31], v13
    v_exp_f32 v35, v35
    v_exp_f32 v36, v36
    v_exp_f32 v37, v37
    v_exp_f32 v38, v38
    v_exp_f32 v39, v39
    v_exp_f32 v40, v40
    v_exp_f32 v41, v41
    v_smfmac_f32_32x32x32_bf16 v[104:119], v[144:147], v[32:39], v13
    s_mov_b64 exec, s[64:65]
    ds_read_b128 v[140:143], v15 offset:9216
    ds_read_b128 v[144:147], v15 offset:9728
    s_mov_b64 exec, -1
    v_exp_f32 v42, v42
    v_exp_f32 v43, v43
    v_exp_f32 v44, v44
    v_exp_f32 v45, v45
    s_waitcnt lgkmcnt(2)
    v_mfma_f32_32x32x16_bf16 v[24:39], v[136:139], v[16:19], v[120:135]
    ds_read_b128 v[136:139], v14 offset:10240
    v_exp_f32 v46, v46
    v_exp_f32 v47, v47
    v_exp_f32 v48, v48
    v_exp_f32 v49, v49
    v_exp_f32 v50, v50
    v_smfmac_f32_32x32x32_bf16 v[104:119], v[148:151], v[40:47], v13
    v_exp_f32 v51, v51
    v_exp_f32 v52, v52
    v_exp_f32 v53, v53
    v_exp_f32 v54, v54
    v_exp_f32 v55, v55
    v_exp_f32 v24, v24
    v_exp_f32 v25, v25
    v_smfmac_f32_32x32x32_bf16 v[104:119], v[152:155], v[48:55], v13
    s_mov_b64 exec, s[64:65]
    ds_read_b128 v[148:151], v15 offset:11264
    ds_read_b128 v[152:155], v15 offset:11776
    s_mov_b64 exec, -1
    s_setprio 1
    v_exp_f32 v26, v26
    v_exp_f32 v27, v27
    v_exp_f32 v28, v28
    v_exp_f32 v29, v29
    s_waitcnt lgkmcnt(2)
    v_mfma_f32_32x32x16_bf16 v[40:55], v[136:139], v[16:19], v[120:135]
    ds_read_b128 v[136:139], v14 offset:12288
    v_exp_f32 v30, v30
    v_exp_f32 v31, v31
    v_exp_f32 v32, v32
    v_exp_f32 v33, v33
    v_exp_f32 v34, v34
    v_smfmac_f32_32x32x32_bf16 v[104:119], v[140:143], v[24:31], v13
    v_exp_f32 v35, v35
    v_exp_f32 v36, v36
    v_exp_f32 v37, v37
    v_exp_f32 v38, v38
    v_exp_f32 v39, v39
    v_exp_f32 v40, v40
    v_exp_f32 v41, v41
    v_smfmac_f32_32x32x32_bf16 v[104:119], v[144:147], v[32:39], v13
    s_mov_b64 exec, s[64:65]
    ds_read_b128 v[140:143], v15 offset:13312
    ds_read_b128 v[144:147], v15 offset:13824
    s_mov_b64 exec, -1
    s_setprio 0
    v_exp_f32 v42, v42
    v_exp_f32 v43, v43
    v_exp_f32 v44, v44
    v_exp_f32 v45, v45
    s_waitcnt lgkmcnt(2)
    v_mfma_f32_32x32x16_bf16 v[24:39], v[136:139], v[16:19], v[120:135]
    ds_read_b128 v[136:139], v14 offset:14336
    v_exp_f32 v46, v46
    v_exp_f32 v47, v47
    v_exp_f32 v48, v48
    v_exp_f32 v49, v49
    v_exp_f32 v50, v50
    v_smfmac_f32_32x32x32_bf16 v[104:119], v[148:151], v[40:47], v13
    v_exp_f32 v51, v51
    v_exp_f32 v52, v52
    v_exp_f32 v53, v53
    v_exp_f32 v54, v54
    v_exp_f32 v55, v55
    v_exp_f32 v24, v24
    v_exp_f32 v25, v25
    v_smfmac_f32_32x32x32_bf16 v[104:119], v[152:155], v[48:55], v13
    s_mov_b64 exec, s[64:65]
    ds_read_b128 v[148:151], v15 offset:15360
    ds_read_b128 v[152:155], v15 offset:15872
    s_mov_b64 exec, -1
    s_setprio 3
    v_exp_f32 v26, v26
    v_exp_f32 v27, v27
    v_exp_f32 v28, v28
    v_exp_f32 v29, v29
    s_waitcnt lgkmcnt(2)
    v_mfma_f32_32x32x16_bf16 v[40:55], v[136:139], v[16:19], v[120:135]
    s_barrier
    ds_read_b128 v[136:139], v14 offset:16384
    v_exp_f32 v30, v30
    v_exp_f32 v31, v31
    v_exp_f32 v32, v32
    v_exp_f32 v33, v33
    v_exp_f32 v34, v34
    v_smfmac_f32_32x32x32_bf16 v[104:119], v[140:143], v[24:31], v13
    buffer_load_dword v12, v7, s[44:47], s28 offen sc1
    v_exp_f32 v35, v35
    v_exp_f32 v36, v36
    v_exp_f32 v37, v37
    v_exp_f32 v38, v38
    v_exp_f32 v39, v39
    v_exp_f32 v40, v40
    v_exp_f32 v41, v41
    v_smfmac_f32_32x32x32_bf16 v[104:119], v[144:147], v[32:39], v13
    s_mov_b64 exec, s[64:65]
    ds_read_b128 v[140:143], v15 offset:17408
    ds_read_b128 v[144:147], v15 offset:17920
    s_mov_b64 exec, -1
    v_exp_f32 v42, v42
    v_exp_f32 v43, v43
    v_exp_f32 v44, v44
    v_exp_f32 v45, v45
    s_waitcnt lgkmcnt(2)
    v_mfma_f32_32x32x16_bf16 v[24:39], v[136:139], v[16:19], v[120:135]
    ds_read_b128 v[136:139], v14 offset:18432
    buffer_store_dwordx4 v[162:165], v11, s[44:47], s7 offen sc1
    v_exp_f32 v46, v46
    v_exp_f32 v47, v47
    v_exp_f32 v48, v48
    v_exp_f32 v49, v49
    v_exp_f32 v50, v50
    v_smfmac_f32_32x32x32_bf16 v[104:119], v[148:151], v[40:47], v13
    v_exp_f32 v51, v51
    v_exp_f32 v52, v52
    v_exp_f32 v53, v53
    v_exp_f32 v54, v54
    v_exp_f32 v55, v55
    v_exp_f32 v24, v24
    v_exp_f32 v25, v25
    v_smfmac_f32_32x32x32_bf16 v[104:119], v[152:155], v[48:55], v13
    s_mov_b64 exec, s[64:65]
    ds_read_b128 v[148:151], v15 offset:19456
    ds_read_b128 v[152:155], v15 offset:19968
    s_mov_b64 exec, -1
    v_exp_f32 v26, v26
    v_exp_f32 v27, v27
    v_exp_f32 v28, v28
    v_exp_f32 v29, v29
    s_waitcnt lgkmcnt(2)
    v_mfma_f32_32x32x16_bf16 v[40:55], v[136:139], v[16:19], v[120:135]
    ds_read_b128 v[136:139], v14 offset:20480
    buffer_store_dwordx4 v[162:165], v11, s[44:47], s27 offen sc1
    v_exp_f32 v30, v30
    v_exp_f32 v31, v31
    v_exp_f32 v32, v32
    v_exp_f32 v33, v33
    v_exp_f32 v34, v34
    v_smfmac_f32_32x32x32_bf16 v[104:119], v[140:143], v[24:31], v13
    v_exp_f32 v35, v35
    v_exp_f32 v36, v36
    v_exp_f32 v37, v37
    v_exp_f32 v38, v38
    v_exp_f32 v39, v39
    v_exp_f32 v40, v40
    v_exp_f32 v41, v41
    v_smfmac_f32_32x32x32_bf16 v[104:119], v[144:147], v[32:39], v13
    s_mov_b64 exec, s[64:65]
    ds_read_b128 v[140:143], v15 offset:21504
    ds_read_b128 v[144:147], v15 offset:22016
    s_mov_b64 exec, -1
    v_exp_f32 v42, v42
    v_exp_f32 v43, v43
    v_exp_f32 v44, v44
    v_exp_f32 v45, v45
    s_waitcnt lgkmcnt(2)
    v_mfma_f32_32x32x16_bf16 v[24:39], v[136:139], v[16:19], v[120:135]
    ds_read_b128 v[136:139], v14 offset:22528
    v_exp_f32 v46, v46
    v_exp_f32 v47, v47
    v_exp_f32 v48, v48
    v_exp_f32 v49, v49
    v_exp_f32 v50, v50
    v_smfmac_f32_32x32x32_bf16 v[104:119], v[148:151], v[40:47], v13
    v_exp_f32 v51, v51
    v_exp_f32 v52, v52
    v_exp_f32 v53, v53
    v_exp_f32 v54, v54
    v_exp_f32 v55, v55
    v_exp_f32 v24, v24
    v_exp_f32 v25, v25
    v_smfmac_f32_32x32x32_bf16 v[104:119], v[152:155], v[48:55], v13
    s_mov_b64 exec, s[64:65]
    ds_read_b128 v[148:151], v15 offset:23552
    ds_read_b128 v[152:155], v15 offset:24064
    s_mov_b64 exec, -1
    s_setprio 2
    v_exp_f32 v26, v26
    v_exp_f32 v27, v27
    v_exp_f32 v28, v28
    v_exp_f32 v29, v29
    s_waitcnt lgkmcnt(2)
    v_mfma_f32_32x32x16_bf16 v[40:55], v[136:139], v[16:19], v[120:135]
    ds_read_b128 v[136:139], v14 offset:24576
    v_exp_f32 v30, v30
    v_exp_f32 v31, v31
    v_exp_f32 v32, v32
    v_exp_f32 v33, v33
    v_exp_f32 v34, v34
    v_smfmac_f32_32x32x32_bf16 v[104:119], v[140:143], v[24:31], v13
    v_exp_f32 v35, v35
    v_exp_f32 v36, v36
    v_exp_f32 v37, v37
    v_exp_f32 v38, v38
    v_exp_f32 v39, v39
    v_exp_f32 v40, v40
    v_exp_f32 v41, v41
    v_smfmac_f32_32x32x32_bf16 v[104:119], v[144:147], v[32:39], v13
    s_mov_b64 exec, s[64:65]
    ds_read_b128 v[140:143], v15 offset:25600
    ds_read_b128 v[144:147], v15 offset:26112
    s_mov_b64 exec, -1
    v_exp_f32 v42, v42
    v_exp_f32 v43, v43
    v_exp_f32 v44, v44
    v_exp_f32 v45, v45
    s_waitcnt lgkmcnt(2)
    v_mfma_f32_32x32x16_bf16 v[24:39], v[136:139], v[16:19], v[120:135]
    ds_read_b128 v[136:139], v14 offset:26624
    v_exp_f32 v46, v46
    v_exp_f32 v47, v47
    v_exp_f32 v48, v48
    v_exp_f32 v49, v49
    v_exp_f32 v50, v50
    v_smfmac_f32_32x32x32_bf16 v[104:119], v[148:151], v[40:47], v13
    v_exp_f32 v51, v51
    v_exp_f32 v52, v52
    v_exp_f32 v53, v53
    v_exp_f32 v54, v54
    v_exp_f32 v55, v55
    v_exp_f32 v24, v24
    v_exp_f32 v25, v25
    v_smfmac_f32_32x32x32_bf16 v[104:119], v[152:155], v[48:55], v13
    s_mov_b64 exec, s[64:65]
    ds_read_b128 v[148:151], v15 offset:27648
    ds_read_b128 v[152:155], v15 offset:28160
    s_mov_b64 exec, -1
    s_setprio 1
    v_exp_f32 v26, v26
    v_exp_f32 v27, v27
    v_exp_f32 v28, v28
    v_exp_f32 v29, v29
    s_waitcnt lgkmcnt(2)
    v_mfma_f32_32x32x16_bf16 v[40:55], v[136:139], v[16:19], v[120:135]
    ds_read_b128 v[136:139], v14 offset:28672
    v_exp_f32 v30, v30
    v_exp_f32 v31, v31
    v_exp_f32 v32, v32
    v_exp_f32 v33, v33
    v_exp_f32 v34, v34
    v_smfmac_f32_32x32x32_bf16 v[104:119], v[140:143], v[24:31], v13
    v_exp_f32 v35, v35
    v_exp_f32 v36, v36
    v_exp_f32 v37, v37
    v_exp_f32 v38, v38
    v_exp_f32 v39, v39
    v_exp_f32 v40, v40
    v_exp_f32 v41, v41
    v_smfmac_f32_32x32x32_bf16 v[104:119], v[144:147], v[32:39], v13
    s_mov_b64 exec, s[64:65]
    ds_read_b128 v[140:143], v15 offset:29696
    ds_read_b128 v[144:147], v15 offset:30208
    s_mov_b64 exec, -1
    s_setprio 0
    v_exp_f32 v42, v42
    v_exp_f32 v43, v43
    v_exp_f32 v44, v44
    v_exp_f32 v45, v45
    s_waitcnt lgkmcnt(2)
    v_mfma_f32_32x32x16_bf16 v[24:39], v[136:139], v[16:19], v[120:135]
    ds_read_b128 v[136:139], v14 offset:30720
    v_exp_f32 v46, v46
    v_exp_f32 v47, v47
    v_exp_f32 v48, v48
    v_exp_f32 v49, v49
    v_exp_f32 v50, v50
    v_smfmac_f32_32x32x32_bf16 v[104:119], v[148:151], v[40:47], v13
    v_exp_f32 v51, v51
    v_exp_f32 v52, v52
    v_exp_f32 v53, v53
    v_exp_f32 v54, v54
    v_exp_f32 v55, v55
    v_exp_f32 v24, v24
    v_exp_f32 v25, v25
    v_smfmac_f32_32x32x32_bf16 v[104:119], v[152:155], v[48:55], v13
    s_mov_b64 exec, s[64:65]
    ds_read_b128 v[148:151], v15 offset:31744
    ds_read_b128 v[152:155], v15 offset:32256
    s_mov_b64 exec, -1
    s_setprio 3
    v_exp_f32 v26, v26
    v_exp_f32 v27, v27
    v_exp_f32 v28, v28
    v_exp_f32 v29, v29
    s_waitcnt lgkmcnt(2)
    v_mfma_f32_32x32x16_bf16 v[40:55], v[136:139], v[16:19], v[120:135]
    ds_read_b128 v[136:139], v14 offset:32768
    v_exp_f32 v30, v30
    v_exp_f32 v31, v31
    v_exp_f32 v32, v32
    v_exp_f32 v33, v33
    v_exp_f32 v34, v34
    v_smfmac_f32_32x32x32_bf16 v[104:119], v[140:143], v[24:31], v13
    v_exp_f32 v35, v35
    v_exp_f32 v36, v36
    v_exp_f32 v37, v37
    v_exp_f32 v38, v38
    v_exp_f32 v39, v39
    v_exp_f32 v40, v40
    v_exp_f32 v41, v41
    v_smfmac_f32_32x32x32_bf16 v[104:119], v[144:147], v[32:39], v13
    s_mov_b64 exec, s[64:65]
    ds_read_b128 v[140:143], v15 offset:33792
    ds_read_b128 v[144:147], v15 offset:34304
    s_mov_b64 exec, -1
    v_exp_f32 v42, v42
    v_exp_f32 v43, v43
    v_exp_f32 v44, v44
    v_exp_f32 v45, v45
    s_waitcnt lgkmcnt(2)
    v_mfma_f32_32x32x16_bf16 v[24:39], v[136:139], v[16:19], v[120:135]
    ds_read_b128 v[136:139], v14 offset:34816
    v_exp_f32 v46, v46
    v_exp_f32 v47, v47
    v_exp_f32 v48, v48
    v_exp_f32 v49, v49
    v_exp_f32 v50, v50
    v_smfmac_f32_32x32x32_bf16 v[104:119], v[148:151], v[40:47], v13
    v_exp_f32 v51, v51
    v_exp_f32 v52, v52
    v_exp_f32 v53, v53
    v_exp_f32 v54, v54
    v_exp_f32 v55, v55
    v_exp_f32 v24, v24
    v_exp_f32 v25, v25
    v_smfmac_f32_32x32x32_bf16 v[104:119], v[152:155], v[48:55], v13
    s_mov_b64 exec, s[64:65]
    ds_read_b128 v[148:151], v15 offset:35840
    ds_read_b128 v[152:155], v15 offset:36352
    s_mov_b64 exec, -1
    v_exp_f32 v26, v26
    v_exp_f32 v27, v27
    v_exp_f32 v28, v28
    v_exp_f32 v29, v29
    s_waitcnt lgkmcnt(2)
    v_mfma_f32_32x32x16_bf16 v[40:55], v[136:139], v[16:19], v[120:135]
    ds_read_b128 v[136:139], v14 offset:36864
    v_exp_f32 v30, v30
    v_exp_f32 v31, v31
    v_exp_f32 v32, v32
    v_exp_f32 v33, v33
    v_exp_f32 v34, v34
    v_smfmac_f32_32x32x32_bf16 v[104:119], v[140:143], v[24:31], v13
    v_exp_f32 v35, v35
    v_exp_f32 v36, v36
    v_exp_f32 v37, v37
    v_exp_f32 v38, v38
    v_exp_f32 v39, v39
    v_exp_f32 v40, v40
    v_exp_f32 v41, v41
    v_smfmac_f32_32x32x32_bf16 v[104:119], v[144:147], v[32:39], v13
    s_mov_b64 exec, s[64:65]
    ds_read_b128 v[140:143], v15 offset:37888
    ds_read_b128 v[144:147], v15 offset:38400
    s_mov_b64 exec, -1
    v_exp_f32 v42, v42
    v_exp_f32 v43, v43
    v_exp_f32 v44, v44
    v_exp_f32 v45, v45
    s_waitcnt lgkmcnt(2)
    v_mfma_f32_32x32x16_bf16 v[24:39], v[136:139], v[16:19], v[120:135]
    ds_read_b128 v[136:139], v14 offset:38912
    v_exp_f32 v46, v46
    v_exp_f32 v47, v47
    v_exp_f32 v48, v48
    v_exp_f32 v49, v49
    v_exp_f32 v50, v50
    v_smfmac_f32_32x32x32_bf16 v[104:119], v[148:151], v[40:47], v13
    v_exp_f32 v51, v51
    v_exp_f32 v52, v52
    v_exp_f32 v53, v53
    v_exp_f32 v54, v54
    v_exp_f32 v55, v55
    v_exp_f32 v24, v24
    v_exp_f32 v25, v25
    v_smfmac_f32_32x32x32_bf16 v[104:119], v[152:155], v[48:55], v13
    s_mov_b64 exec, s[64:65]
    ds_read_b128 v[148:151], v15 offset:39936
    ds_read_b128 v[152:155], v15 offset:40448
    s_mov_b64 exec, -1
    s_setprio 2
    v_exp_f32 v26, v26
    v_exp_f32 v27, v27
    v_exp_f32 v28, v28
    v_exp_f32 v29, v29
    s_waitcnt lgkmcnt(2)
    v_mfma_f32_32x32x16_bf16 v[40:55], v[136:139], v[16:19], v[120:135]
    ds_read_b128 v[136:139], v14 offset:40960
    s_waitcnt vmcnt(0)
    s_mov_b64 exec, 1
    buffer_store_dword v158, v156, s[44:47], s29 offen sc1
    s_mov_b64 exec, -1
    v_exp_f32 v30, v30
    v_exp_f32 v31, v31
    v_exp_f32 v32, v32
    v_exp_f32 v33, v33
    v_exp_f32 v34, v34
    v_smfmac_f32_32x32x32_bf16 v[104:119], v[140:143], v[24:31], v13
    v_exp_f32 v35, v35
    v_exp_f32 v36, v36
    v_exp_f32 v37, v37
    v_exp_f32 v38, v38
    v_exp_f32 v39, v39
    v_exp_f32 v40, v40
    v_exp_f32 v41, v41
    v_smfmac_f32_32x32x32_bf16 v[104:119], v[144:147], v[32:39], v13
    s_mov_b64 exec, s[64:65]
    ds_read_b128 v[140:143], v15 offset:41984
    ds_read_b128 v[144:147], v15 offset:42496
    s_mov_b64 exec, -1
    v_exp_f32 v42, v42
    v_exp_f32 v43, v43
    v_exp_f32 v44, v44
    v_exp_f32 v45, v45
    s_waitcnt lgkmcnt(2)
    v_mfma_f32_32x32x16_bf16 v[24:39], v[136:139], v[16:19], v[120:135]
    ds_read_b128 v[136:139], v14 offset:43008
    v_exp_f32 v46, v46
    v_exp_f32 v47, v47
    v_exp_f32 v48, v48
    v_exp_f32 v49, v49
    v_exp_f32 v50, v50
    v_smfmac_f32_32x32x32_bf16 v[104:119], v[148:151], v[40:47], v13
    v_exp_f32 v51, v51
    v_exp_f32 v52, v52
    v_exp_f32 v53, v53
    v_exp_f32 v54, v54
    v_exp_f32 v55, v55
    v_exp_f32 v24, v24
    v_exp_f32 v25, v25
    v_smfmac_f32_32x32x32_bf16 v[104:119], v[152:155], v[48:55], v13
    s_mov_b64 exec, s[64:65]
    ds_read_b128 v[148:151], v15 offset:44032
    ds_read_b128 v[152:155], v15 offset:44544
    s_mov_b64 exec, -1
    s_setprio 1
    v_exp_f32 v26, v26
    v_exp_f32 v27, v27
    v_exp_f32 v28, v28
    v_exp_f32 v29, v29
    s_waitcnt lgkmcnt(2)
    v_mfma_f32_32x32x16_bf16 v[40:55], v[136:139], v[16:19], v[120:135]
    ds_read_b128 v[136:139], v14 offset:45056
    v_exp_f32 v30, v30
    v_exp_f32 v31, v31
    v_exp_f32 v32, v32
    v_exp_f32 v33, v33
    v_exp_f32 v34, v34
    v_smfmac_f32_32x32x32_bf16 v[104:119], v[140:143], v[24:31], v13
    v_exp_f32 v35, v35
    v_exp_f32 v36, v36
    v_exp_f32 v37, v37
    v_exp_f32 v38, v38
    v_exp_f32 v39, v39
    v_exp_f32 v40, v40
    v_exp_f32 v41, v41
    v_smfmac_f32_32x32x32_bf16 v[104:119], v[144:147], v[32:39], v13
    s_mov_b64 exec, s[64:65]
    ds_read_b128 v[140:143], v15 offset:46080
    ds_read_b128 v[144:147], v15 offset:46592
    s_mov_b64 exec, -1
    s_setprio 0
    v_exp_f32 v42, v42
    v_exp_f32 v43, v43
    v_exp_f32 v44, v44
    v_exp_f32 v45, v45
    s_waitcnt lgkmcnt(2)
    v_mfma_f32_32x32x16_bf16 v[24:39], v[136:139], v[16:19], v[120:135]
    ds_read_b128 v[136:139], v14 offset:47104
    v_exp_f32 v46, v46
    v_exp_f32 v47, v47
    v_exp_f32 v48, v48
    v_exp_f32 v49, v49
    v_exp_f32 v50, v50
    v_smfmac_f32_32x32x32_bf16 v[104:119], v[148:151], v[40:47], v13
    v_exp_f32 v51, v51
    v_exp_f32 v52, v52
    v_exp_f32 v53, v53
    v_exp_f32 v54, v54
    v_exp_f32 v55, v55
    v_exp_f32 v24, v24
    v_exp_f32 v25, v25
    v_smfmac_f32_32x32x32_bf16 v[104:119], v[152:155], v[48:55], v13
    s_mov_b64 exec, s[64:65]
    ds_read_b128 v[148:151], v15 offset:48128
    ds_read_b128 v[152:155], v15 offset:48640
    s_mov_b64 exec, -1
    s_setprio 3
    v_exp_f32 v26, v26
    v_exp_f32 v27, v27
    v_exp_f32 v28, v28
    v_exp_f32 v29, v29
    s_waitcnt lgkmcnt(2)
    v_mfma_f32_32x32x16_bf16 v[40:55], v[136:139], v[16:19], v[120:135]
    ds_read_b128 v[136:139], v14 offset:49152
    v_exp_f32 v30, v30
    v_exp_f32 v31, v31
    v_exp_f32 v32, v32
    v_exp_f32 v33, v33
    v_exp_f32 v34, v34
    v_smfmac_f32_32x32x32_bf16 v[104:119], v[140:143], v[24:31], v13
    v_exp_f32 v35, v35
    v_exp_f32 v36, v36
    v_exp_f32 v37, v37
    v_exp_f32 v38, v38
    v_exp_f32 v39, v39
    v_exp_f32 v40, v40
    v_exp_f32 v41, v41
    v_smfmac_f32_32x32x32_bf16 v[104:119], v[144:147], v[32:39], v13
    s_mov_b64 exec, s[64:65]
    ds_read_b128 v[140:143], v15 offset:50176
    ds_read_b128 v[144:147], v15 offset:50688
    s_mov_b64 exec, -1
    v_exp_f32 v42, v42
    v_exp_f32 v43, v43
    v_exp_f32 v44, v44
    v_exp_f32 v45, v45
    s_waitcnt lgkmcnt(2)
    v_mfma_f32_32x32x16_bf16 v[24:39], v[136:139], v[16:19], v[120:135]
    ds_read_b128 v[136:139], v14 offset:51200
    v_exp_f32 v46, v46
    v_exp_f32 v47, v47
    v_exp_f32 v48, v48
    v_exp_f32 v49, v49
    v_exp_f32 v50, v50
    v_smfmac_f32_32x32x32_bf16 v[104:119], v[148:151], v[40:47], v13
    v_exp_f32 v51, v51
    v_exp_f32 v52, v52
    v_exp_f32 v53, v53
    v_exp_f32 v54, v54
    v_exp_f32 v55, v55
    v_exp_f32 v24, v24
    v_exp_f32 v25, v25
    v_smfmac_f32_32x32x32_bf16 v[104:119], v[152:155], v[48:55], v13
    s_mov_b64 exec, s[64:65]
    ds_read_b128 v[148:151], v15 offset:52224
    ds_read_b128 v[152:155], v15 offset:52736
    s_mov_b64 exec, -1
    v_exp_f32 v26, v26
    v_exp_f32 v27, v27
    v_exp_f32 v28, v28
    v_exp_f32 v29, v29
    s_waitcnt lgkmcnt(2)
    v_mfma_f32_32x32x16_bf16 v[40:55], v[136:139], v[16:19], v[120:135]
    ds_read_b128 v[136:139], v14 offset:53248
    v_exp_f32 v30, v30
    v_exp_f32 v31, v31
    v_exp_f32 v32, v32
    v_exp_f32 v33, v33
    v_exp_f32 v34, v34
    v_smfmac_f32_32x32x32_bf16 v[104:119], v[140:143], v[24:31], v13
    v_exp_f32 v35, v35
    v_exp_f32 v36, v36
    v_exp_f32 v37, v37
    v_exp_f32 v38, v38
    v_exp_f32 v39, v39
    v_exp_f32 v40, v40
    v_exp_f32 v41, v41
    v_smfmac_f32_32x32x32_bf16 v[104:119], v[144:147], v[32:39], v13
    s_mov_b64 exec, s[64:65]
    ds_read_b128 v[140:143], v15 offset:54272
    ds_read_b128 v[144:147], v15 offset:54784
    s_mov_b64 exec, -1
    v_exp_f32 v42, v42
    v_exp_f32 v43, v43
    v_exp_f32 v44, v44
    v_exp_f32 v45, v45
    s_waitcnt lgkmcnt(2)
    v_mfma_f32_32x32x16_bf16 v[24:39], v[136:139], v[16:19], v[120:135]
    ds_read_b128 v[136:139], v14 offset:55296
    v_exp_f32 v46, v46
    v_exp_f32 v47, v47
    v_exp_f32 v48, v48
    v_exp_f32 v49, v49
    v_exp_f32 v50, v50
    v_smfmac_f32_32x32x32_bf16 v[104:119], v[148:151], v[40:47], v13
    v_exp_f32 v51, v51
    v_exp_f32 v52, v52
    v_exp_f32 v53, v53
    v_exp_f32 v54, v54
    v_exp_f32 v55, v55
    v_exp_f32 v24, v24
    v_exp_f32 v25, v25
    v_smfmac_f32_32x32x32_bf16 v[104:119], v[152:155], v[48:55], v13
    s_mov_b64 exec, s[64:65]
    ds_read_b128 v[148:151], v15 offset:56320
    ds_read_b128 v[152:155], v15 offset:56832
    s_mov_b64 exec, -1
    s_setprio 2
    v_exp_f32 v26, v26
    v_exp_f32 v27, v27
    v_exp_f32 v28, v28
    v_exp_f32 v29, v29
    s_waitcnt lgkmcnt(2)
    v_mfma_f32_32x32x16_bf16 v[40:55], v[136:139], v[16:19], v[120:135]
    ds_read_b128 v[136:139], v14 offset:57344
    v_exp_f32 v30, v30
    v_exp_f32 v31, v31
    v_exp_f32 v32, v32
    v_exp_f32 v33, v33
    v_exp_f32 v34, v34
    v_smfmac_f32_32x32x32_bf16 v[104:119], v[140:143], v[24:31], v13
    v_exp_f32 v35, v35
    v_exp_f32 v36, v36
    v_exp_f32 v37, v37
    v_exp_f32 v38, v38
    v_exp_f32 v39, v39
    v_exp_f32 v40, v40
    v_exp_f32 v41, v41
    v_smfmac_f32_32x32x32_bf16 v[104:119], v[144:147], v[32:39], v13
    s_mov_b64 exec, s[64:65]
    ds_read_b128 v[140:143], v15 offset:58368
    ds_read_b128 v[144:147], v15 offset:58880
    s_mov_b64 exec, -1
    v_exp_f32 v42, v42
    v_exp_f32 v43, v43
    v_exp_f32 v44, v44
    v_exp_f32 v45, v45
    s_waitcnt lgkmcnt(2)
    v_mfma_f32_32x32x16_bf16 v[24:39], v[136:139], v[16:19], v[120:135]
    ds_read_b128 v[136:139], v14 offset:59392
    v_exp_f32 v46, v46
    v_exp_f32 v47, v47
    v_exp_f32 v48, v48
    v_exp_f32 v49, v49
    v_exp_f32 v50, v50
    v_smfmac_f32_32x32x32_bf16 v[104:119], v[148:151], v[40:47], v13
    v_exp_f32 v51, v51
    v_exp_f32 v52, v52
    v_exp_f32 v53, v53
    v_exp_f32 v54, v54
    v_exp_f32 v55, v55
    v_exp_f32 v24, v24
    v_exp_f32 v25, v25
    v_smfmac_f32_32x32x32_bf16 v[104:119], v[152:155], v[48:55], v13
    s_mov_b64 exec, s[64:65]
    ds_read_b128 v[148:151], v15 offset:60416
    ds_read_b128 v[152:155], v15 offset:60928
    s_mov_b64 exec, -1
    s_setprio 1
    v_exp_f32 v26, v26
    v_exp_f32 v27, v27
    v_exp_f32 v28, v28
    v_exp_f32 v29, v29
    s_waitcnt lgkmcnt(2)
    v_mfma_f32_32x32x16_bf16 v[40:55], v[136:139], v[16:19], v[120:135]
    ds_read_b128 v[136:139], v14 offset:61440
    v_exp_f32 v30, v30
    v_exp_f32 v31, v31
    v_exp_f32 v32, v32
    v_exp_f32 v33, v33
    v_exp_f32 v34, v34
    v_smfmac_f32_32x32x32_bf16 v[104:119], v[140:143], v[24:31], v13
    v_exp_f32 v35, v35
    v_exp_f32 v36, v36
    v_exp_f32 v37, v37
    v_exp_f32 v38, v38
    v_exp_f32 v39, v39
    v_exp_f32 v40, v40
    v_exp_f32 v41, v41
    v_smfmac_f32_32x32x32_bf16 v[104:119], v[144:147], v[32:39], v13
    s_mov_b64 exec, s[64:65]
    ds_read_b128 v[140:143], v15 offset:62464
    ds_read_b128 v[144:147], v15 offset:62976
    s_mov_b64 exec, -1
    s_setprio 0
    v_exp_f32 v42, v42
    v_exp_f32 v43, v43
    v_exp_f32 v44, v44
    v_exp_f32 v45, v45
    s_waitcnt lgkmcnt(2)
    v_mfma_f32_32x32x16_bf16 v[24:39], v[136:139], v[16:19], v[120:135]
    ds_read_b128 v[136:139], v14 offset:63488
    v_exp_f32 v46, v46
    v_exp_f32 v47, v47
    v_exp_f32 v48, v48
    v_exp_f32 v49, v49
    v_exp_f32 v50, v50
    v_smfmac_f32_32x32x32_bf16 v[104:119], v[148:151], v[40:47], v13
    v_exp_f32 v51, v51
    v_exp_f32 v52, v52
    v_exp_f32 v53, v53
    v_exp_f32 v54, v54
    v_exp_f32 v55, v55
    v_exp_f32 v24, v24
    v_exp_f32 v25, v25
    v_smfmac_f32_32x32x32_bf16 v[104:119], v[152:155], v[48:55], v13
    s_mov_b64 exec, s[64:65]
    ds_read_b128 v[148:151], v15 offset:64512
    ds_read_b128 v[152:155], v15 offset:65024
    s_mov_b64 exec, -1
    s_setprio 3
    v_exp_f32 v26, v26
    v_exp_f32 v27, v27
    v_exp_f32 v28, v28
    v_exp_f32 v29, v29
    s_waitcnt lgkmcnt(0)
    v_mfma_f32_32x32x16_bf16 v[40:55], v[136:139], v[16:19], v[120:135]
    v_add_u32 v14, 0x10000, v14
    v_add_u32 v15, 0x10000, v15
    s_barrier
    ds_read_b128 v[136:139], v14 offset:0
    v_exp_f32 v30, v30
    v_exp_f32 v31, v31
    v_exp_f32 v32, v32
    v_exp_f32 v33, v33
    v_exp_f32 v34, v34
    v_smfmac_f32_32x32x32_bf16 v[104:119], v[140:143], v[24:31], v13
    v_exp_f32 v35, v35
    v_exp_f32 v36, v36
    v_exp_f32 v37, v37
    v_exp_f32 v38, v38
    v_exp_f32 v39, v39
    v_exp_f32 v40, v40
    v_exp_f32 v41, v41
    v_smfmac_f32_32x32x32_bf16 v[104:119], v[144:147], v[32:39], v13
    s_mov_b64 exec, s[64:65]
    ds_read_b128 v[140:143], v15 offset:1024
    ds_read_b128 v[144:147], v15 offset:1536
    s_mov_b64 exec, -1
    v_exp_f32 v42, v42
    v_exp_f32 v43, v43
    v_exp_f32 v44, v44
    v_exp_f32 v45, v45
    s_waitcnt lgkmcnt(2)
    v_mfma_f32_32x32x16_bf16 v[24:39], v[136:139], v[16:19], v[120:135]
    ds_read_b128 v[136:139], v14 offset:2048
    v_exp_f32 v46, v46
    v_exp_f32 v47, v47
    v_exp_f32 v48, v48
    v_exp_f32 v49, v49
    v_exp_f32 v50, v50
    v_smfmac_f32_32x32x32_bf16 v[104:119], v[148:151], v[40:47], v13
    v_exp_f32 v51, v51
    v_exp_f32 v52, v52
    v_exp_f32 v53, v53
    v_exp_f32 v54, v54
    v_exp_f32 v55, v55
    v_exp_f32 v24, v24
    v_exp_f32 v25, v25
    v_smfmac_f32_32x32x32_bf16 v[104:119], v[152:155], v[48:55], v13
    s_mov_b64 exec, s[64:65]
    ds_read_b128 v[148:151], v15 offset:3072
    ds_read_b128 v[152:155], v15 offset:3584
    s_mov_b64 exec, -1
    v_exp_f32 v26, v26
    v_exp_f32 v27, v27
    v_exp_f32 v28, v28
    v_exp_f32 v29, v29
    s_waitcnt lgkmcnt(2)
    v_mfma_f32_32x32x16_bf16 v[40:55], v[136:139], v[16:19], v[120:135]
    ds_read_b128 v[136:139], v14 offset:4096
    v_exp_f32 v30, v30
    v_exp_f32 v31, v31
    v_exp_f32 v32, v32
    v_exp_f32 v33, v33
    v_exp_f32 v34, v34
    v_smfmac_f32_32x32x32_bf16 v[104:119], v[140:143], v[24:31], v13
    v_exp_f32 v35, v35
    v_exp_f32 v36, v36
    v_exp_f32 v37, v37
    v_exp_f32 v38, v38
    v_exp_f32 v39, v39
    v_exp_f32 v40, v40
    v_exp_f32 v41, v41
    v_smfmac_f32_32x32x32_bf16 v[104:119], v[144:147], v[32:39], v13
    s_mov_b64 exec, s[64:65]
    ds_read_b128 v[140:143], v15 offset:5120
    ds_read_b128 v[144:147], v15 offset:5632
    s_mov_b64 exec, -1
    v_exp_f32 v42, v42
    v_exp_f32 v43, v43
    v_exp_f32 v44, v44
    v_exp_f32 v45, v45
    s_waitcnt lgkmcnt(2)
    v_mfma_f32_32x32x16_bf16 v[24:39], v[136:139], v[16:19], v[120:135]
    ds_read_b128 v[136:139], v14 offset:6144
    v_exp_f32 v46, v46
    v_exp_f32 v47, v47
    v_exp_f32 v48, v48
    v_exp_f32 v49, v49
    v_exp_f32 v50, v50
    v_smfmac_f32_32x32x32_bf16 v[104:119], v[148:151], v[40:47], v13
    v_exp_f32 v51, v51
    v_exp_f32 v52, v52
    v_exp_f32 v53, v53
    v_exp_f32 v54, v54
    v_exp_f32 v55, v55
    v_exp_f32 v24, v24
    v_exp_f32 v25, v25
    v_smfmac_f32_32x32x32_bf16 v[104:119], v[152:155], v[48:55], v13
    s_mov_b64 exec, s[64:65]
    ds_read_b128 v[148:151], v15 offset:7168
    ds_read_b128 v[152:155], v15 offset:7680
    s_mov_b64 exec, -1
    s_setprio 2
    v_exp_f32 v26, v26
    v_exp_f32 v27, v27
    v_exp_f32 v28, v28
    v_exp_f32 v29, v29
    s_waitcnt lgkmcnt(2)
    v_mfma_f32_32x32x16_bf16 v[40:55], v[136:139], v[16:19], v[120:135]
    ds_read_b128 v[136:139], v14 offset:8192
    v_exp_f32 v30, v30
    v_exp_f32 v31, v31
    v_exp_f32 v32, v32
    v_exp_f32 v33, v33
    v_exp_f32 v34, v34
    v_smfmac_f32_32x32x32_bf16 v[104:119], v[140:143], v[24:31], v13
    v_exp_f32 v35, v35
    v_exp_f32 v36, v36
    v_exp_f32 v37, v37
    v_exp_f32 v38, v38
    v_exp_f32 v39, v39
    v_exp_f32 v40, v40
    v_exp_f32 v41, v41
    v_smfmac_f32_32x32x32_bf16 v[104:119], v[144:147], v[32:39], v13
    s_mov_b64 exec, s[64:65]
    ds_read_b128 v[140:143], v15 offset:9216
    ds_read_b128 v[144:147], v15 offset:9728
    s_mov_b64 exec, -1
    v_exp_f32 v42, v42
    v_exp_f32 v43, v43
    v_exp_f32 v44, v44
    v_exp_f32 v45, v45
    s_waitcnt lgkmcnt(2)
    v_mfma_f32_32x32x16_bf16 v[24:39], v[136:139], v[16:19], v[120:135]
    ds_read_b128 v[136:139], v14 offset:10240
    v_exp_f32 v46, v46
    v_exp_f32 v47, v47
    v_exp_f32 v48, v48
    v_exp_f32 v49, v49
    v_exp_f32 v50, v50
    v_smfmac_f32_32x32x32_bf16 v[104:119], v[148:151], v[40:47], v13
    v_exp_f32 v51, v51
    v_exp_f32 v52, v52
    v_exp_f32 v53, v53
    v_exp_f32 v54, v54
    v_exp_f32 v55, v55
    v_exp_f32 v24, v24
    v_exp_f32 v25, v25
    v_smfmac_f32_32x32x32_bf16 v[104:119], v[152:155], v[48:55], v13
    s_mov_b64 exec, s[64:65]
    ds_read_b128 v[148:151], v15 offset:11264
    ds_read_b128 v[152:155], v15 offset:11776
    s_mov_b64 exec, -1
    s_setprio 1
    v_exp_f32 v26, v26
    v_exp_f32 v27, v27
    v_exp_f32 v28, v28
    v_exp_f32 v29, v29
    s_waitcnt lgkmcnt(2)
    v_mfma_f32_32x32x16_bf16 v[40:55], v[136:139], v[16:19], v[120:135]
    ds_read_b128 v[136:139], v14 offset:12288
    s_mov_b32 exec_hi, 0
    buffer_load_dword v157, v156, s[44:47], s30 offen sc1
    s_mov_b32 exec_hi, -1
    v_exp_f32 v30, v30
    v_exp_f32 v31, v31
    v_exp_f32 v32, v32
    v_exp_f32 v33, v33
    v_exp_f32 v34, v34
    v_smfmac_f32_32x32x32_bf16 v[104:119], v[140:143], v[24:31], v13
    v_exp_f32 v35, v35
    v_exp_f32 v36, v36
    v_exp_f32 v37, v37
    v_exp_f32 v38, v38
    v_exp_f32 v39, v39
    v_exp_f32 v40, v40
    v_exp_f32 v41, v41
    v_smfmac_f32_32x32x32_bf16 v[104:119], v[144:147], v[32:39], v13
    s_mov_b64 exec, s[64:65]
    ds_read_b128 v[140:143], v15 offset:13312
    ds_read_b128 v[144:147], v15 offset:13824
    s_mov_b64 exec, -1
    s_setprio 0
    v_exp_f32 v42, v42
    v_exp_f32 v43, v43
    v_exp_f32 v44, v44
    v_exp_f32 v45, v45
    s_waitcnt lgkmcnt(2)
    v_mfma_f32_32x32x16_bf16 v[24:39], v[136:139], v[16:19], v[120:135]
    ds_read_b128 v[136:139], v14 offset:14336
    v_exp_f32 v46, v46
    v_exp_f32 v47, v47
    v_exp_f32 v48, v48
    v_exp_f32 v49, v49
    v_exp_f32 v50, v50
    v_smfmac_f32_32x32x32_bf16 v[104:119], v[148:151], v[40:47], v13
    v_exp_f32 v51, v51
    v_exp_f32 v52, v52
    v_exp_f32 v53, v53
    v_exp_f32 v54, v54
    v_exp_f32 v55, v55
    v_exp_f32 v24, v24
    v_exp_f32 v25, v25
    v_smfmac_f32_32x32x32_bf16 v[104:119], v[152:155], v[48:55], v13
    s_mov_b64 exec, s[64:65]
    ds_read_b128 v[148:151], v15 offset:15360
    ds_read_b128 v[152:155], v15 offset:15872
    s_mov_b64 exec, -1
    s_setprio 3
    v_exp_f32 v26, v26
    v_exp_f32 v27, v27
    v_exp_f32 v28, v28
    v_exp_f32 v29, v29
    s_waitcnt lgkmcnt(2)
    v_mfma_f32_32x32x16_bf16 v[40:55], v[136:139], v[16:19], v[120:135]
    s_barrier
    ds_read_b128 v[136:139], v14 offset:16384
    buffer_load_dword v56, v166, s[44:47], s31 offen offset:0 sc1
    v_exp_f32 v30, v30
    v_exp_f32 v31, v31
    v_exp_f32 v32, v32
    v_exp_f32 v33, v33
    v_exp_f32 v34, v34
    v_smfmac_f32_32x32x32_bf16 v[104:119], v[140:143], v[24:31], v13
    buffer_load_dword v57, v166, s[44:47], s31 offen offset:512 sc1
    v_exp_f32 v35, v35
    v_exp_f32 v36, v36
    v_exp_f32 v37, v37
    v_exp_f32 v38, v38
    v_exp_f32 v39, v39
    v_exp_f32 v40, v40
    v_exp_f32 v41, v41
    v_smfmac_f32_32x32x32_bf16 v[104:119], v[144:147], v[32:39], v13
    s_mov_b64 exec, s[64:65]
    ds_read_b128 v[140:143], v15 offset:17408
    ds_read_b128 v[144:147], v15 offset:17920
    s_mov_b64 exec, -1
    v_exp_f32 v42, v42
    v_exp_f32 v43, v43
    v_exp_f32 v44, v44
    v_exp_f32 v45, v45
    s_waitcnt lgkmcnt(2)
    v_mfma_f32_32x32x16_bf16 v[24:39], v[136:139], v[16:19], v[120:135]
    ds_read_b128 v[136:139], v14 offset:18432
    buffer_load_dword v58, v166, s[44:47], s31 offen offset:1024 sc1
    v_exp_f32 v46, v46
    v_exp_f32 v47, v47
    v_exp_f32 v48, v48
    v_exp_f32 v49, v49
    v_exp_f32 v50, v50
    v_smfmac_f32_32x32x32_bf16 v[104:119], v[148:151], v[40:47], v13
    buffer_load_dword v59, v166, s[44:47], s31 offen offset:1536 sc1
    v_exp_f32 v51, v51
    v_exp_f32 v52, v52
    v_exp_f32 v53, v53
    v_exp_f32 v54, v54
    v_exp_f32 v55, v55
    v_exp_f32 v24, v24
    v_exp_f32 v25, v25
    v_smfmac_f32_32x32x32_bf16 v[104:119], v[152:155], v[48:55], v13
    s_mov_b64 exec, s[64:65]
    ds_read_b128 v[148:151], v15 offset:19456
    ds_read_b128 v[152:155], v15 offset:19968
    s_mov_b64 exec, -1
    v_exp_f32 v26, v26
    v_exp_f32 v27, v27
    v_exp_f32 v28, v28
    v_exp_f32 v29, v29
    s_waitcnt lgkmcnt(2)
    v_mfma_f32_32x32x16_bf16 v[40:55], v[136:139], v[16:19], v[120:135]
    ds_read_b128 v[136:139], v14 offset:20480
    buffer_load_dword v60, v166, s[44:47], s31 offen offset:2048 sc1
    v_exp_f32 v30, v30
    v_exp_f32 v31, v31
    v_exp_f32 v32, v32
    v_exp_f32 v33, v33
    v_exp_f32 v34, v34
    v_smfmac_f32_32x32x32_bf16 v[104:119], v[140:143], v[24:31], v13
    buffer_load_dword v61, v166, s[44:47], s31 offen offset:2560 sc1
    v_exp_f32 v35, v35
    v_exp_f32 v36, v36
    v_exp_f32 v37, v37
    v_exp_f32 v38, v38
    v_exp_f32 v39, v39
    v_exp_f32 v40, v40
    v_exp_f32 v41, v41
    v_smfmac_f32_32x32x32_bf16 v[104:119], v[144:147], v[32:39], v13
    s_mov_b64 exec, s[64:65]
    ds_read_b128 v[140:143], v15 offset:21504
    ds_read_b128 v[144:147], v15 offset:22016
    s_mov_b64 exec, -1
    v_exp_f32 v42, v42
    v_exp_f32 v43, v43
    v_exp_f32 v44, v44
    v_exp_f32 v45, v45
    s_waitcnt lgkmcnt(2)
    v_mfma_f32_32x32x16_bf16 v[24:39], v[136:139], v[16:19], v[120:135]
    ds_read_b128 v[136:139], v14 offset:22528
    buffer_load_dword v62, v166, s[44:47], s31 offen offset:3072 sc1
    v_exp_f32 v46, v46
    v_exp_f32 v47, v47
    v_exp_f32 v48, v48
    v_exp_f32 v49, v49
    v_exp_f32 v50, v50
    v_smfmac_f32_32x32x32_bf16 v[104:119], v[148:151], v[40:47], v13
    buffer_load_dword v63, v166, s[44:47], s31 offen offset:3584 sc1
    v_exp_f32 v51, v51
    v_exp_f32 v52, v52
    v_exp_f32 v53, v53
    v_exp_f32 v54, v54
    v_exp_f32 v55, v55
    v_exp_f32 v24, v24
    v_exp_f32 v25, v25
    v_smfmac_f32_32x32x32_bf16 v[104:119], v[152:155], v[48:55], v13
    s_mov_b64 exec, s[64:65]
    ds_read_b128 v[148:151], v15 offset:23552
    ds_read_b128 v[152:155], v15 offset:24064
    s_mov_b64 exec, -1
    s_setprio 2
    v_exp_f32 v26, v26
    v_exp_f32 v27, v27
    v_exp_f32 v28, v28
    v_exp_f32 v29, v29
    s_waitcnt lgkmcnt(2)
    v_mfma_f32_32x32x16_bf16 v[40:55], v[136:139], v[16:19], v[120:135]
    ds_read_b128 v[136:139], v14 offset:24576
    v_exp_f32 v30, v30
    v_exp_f32 v31, v31
    v_exp_f32 v32, v32
    v_exp_f32 v33, v33
    v_exp_f32 v34, v34
    v_smfmac_f32_32x32x32_bf16 v[104:119], v[140:143], v[24:31], v13
    v_exp_f32 v35, v35
    v_exp_f32 v36, v36
    v_exp_f32 v37, v37
    v_exp_f32 v38, v38
    v_exp_f32 v39, v39
    v_exp_f32 v40, v40
    v_exp_f32 v41, v41
    v_smfmac_f32_32x32x32_bf16 v[104:119], v[144:147], v[32:39], v13
    s_mov_b64 exec, s[64:65]
    ds_read_b128 v[140:143], v15 offset:25600
    ds_read_b128 v[144:147], v15 offset:26112
    s_mov_b64 exec, -1
    v_exp_f32 v42, v42
    v_exp_f32 v43, v43
    v_exp_f32 v44, v44
    v_exp_f32 v45, v45
    s_waitcnt lgkmcnt(2)
    v_mfma_f32_32x32x16_bf16 v[24:39], v[136:139], v[16:19], v[120:135]
    ds_read_b128 v[136:139], v14 offset:26624
    v_exp_f32 v46, v46
    v_exp_f32 v47, v47
    v_exp_f32 v48, v48
    v_exp_f32 v49, v49
    v_exp_f32 v50, v50
    v_smfmac_f32_32x32x32_bf16 v[104:119], v[148:151], v[40:47], v13
    v_exp_f32 v51, v51
    v_exp_f32 v52, v52
    v_exp_f32 v53, v53
    v_exp_f32 v54, v54
    v_exp_f32 v55, v55
    v_exp_f32 v24, v24
    v_exp_f32 v25, v25
    v_smfmac_f32_32x32x32_bf16 v[104:119], v[152:155], v[48:55], v13
    s_mov_b64 exec, s[64:65]
    ds_read_b128 v[148:151], v15 offset:27648
    ds_read_b128 v[152:155], v15 offset:28160
    s_mov_b64 exec, -1
    s_setprio 1
    v_exp_f32 v26, v26
    v_exp_f32 v27, v27
    v_exp_f32 v28, v28
    v_exp_f32 v29, v29
    s_waitcnt lgkmcnt(2)
    v_mfma_f32_32x32x16_bf16 v[40:55], v[136:139], v[16:19], v[120:135]
    ds_read_b128 v[136:139], v14 offset:28672
    v_exp_f32 v30, v30
    v_exp_f32 v31, v31
    v_exp_f32 v32, v32
    v_exp_f32 v33, v33
    v_exp_f32 v34, v34
    v_smfmac_f32_32x32x32_bf16 v[104:119], v[140:143], v[24:31], v13
    v_exp_f32 v35, v35
    v_exp_f32 v36, v36
    v_exp_f32 v37, v37
    v_exp_f32 v38, v38
    v_exp_f32 v39, v39
    v_exp_f32 v40, v40
    v_exp_f32 v41, v41
    v_smfmac_f32_32x32x32_bf16 v[104:119], v[144:147], v[32:39], v13
    s_mov_b64 exec, s[64:65]
    ds_read_b128 v[140:143], v15 offset:29696
    ds_read_b128 v[144:147], v15 offset:30208
    s_mov_b64 exec, -1
    s_setprio 0
    v_exp_f32 v42, v42
    v_exp_f32 v43, v43
    v_exp_f32 v44, v44
    v_exp_f32 v45, v45
    s_waitcnt lgkmcnt(2)
    v_mfma_f32_32x32x16_bf16 v[24:39], v[136:139], v[16:19], v[120:135]
    ds_read_b128 v[136:139], v14 offset:30720
    s_waitcnt vmcnt(0)
    v_cvt_pk_bf16_f32 v64, v56, v57
    v_cvt_pk_bf16_f32 v65, v58, v59
    v_cvt_pk_bf16_f32 v66, v60, v61
    v_cvt_pk_bf16_f32 v67, v62, v63
    v_exp_f32 v46, v46
    v_exp_f32 v47, v47
    v_exp_f32 v48, v48
    v_exp_f32 v49, v49
    v_exp_f32 v50, v50
    v_smfmac_f32_32x32x32_bf16 v[104:119], v[148:151], v[40:47], v13
    v_mfma_f32_32x32x16_bf16 v[72:87], v[64:67], v[20:23], 0
    v_exp_f32 v51, v51
    v_exp_f32 v52, v52
    v_exp_f32 v53, v53
    v_exp_f32 v54, v54
    v_exp_f32 v55, v55
    v_exp_f32 v24, v24
    v_exp_f32 v25, v25
    v_smfmac_f32_32x32x32_bf16 v[104:119], v[152:155], v[48:55], v13
    s_mov_b64 exec, s[64:65]
    ds_read_b128 v[148:151], v15 offset:31744
    ds_read_b128 v[152:155], v15 offset:32256
    s_mov_b64 exec, -1
    s_setprio 3
    v_exp_f32 v26, v26
    v_exp_f32 v27, v27
    v_exp_f32 v28, v28
    v_exp_f32 v29, v29
    s_waitcnt lgkmcnt(0)
    v_mfma_f32_32x32x16_bf16 v[40:55], v[136:139], v[16:19], v[120:135]
    s_barrier
    ds_read_b128 v[136:139], v14 offset:32768
    v_exp_f32 v30, v30
    v_exp_f32 v31, v31
    v_exp_f32 v32, v32
    v_exp_f32 v33, v33
    v_exp_f32 v34, v34
    v_smfmac_f32_32x32x32_bf16 v[104:119], v[140:143], v[24:31], v13
    v_add_f32 v2, s20, v72
    v_rcp_f32 v2, v2
    v_exp_f32 v35, v35
    v_exp_f32 v36, v36
    v_exp_f32 v37, v37
    v_exp_f32 v38, v38
    v_exp_f32 v39, v39
    v_exp_f32 v40, v40
    v_exp_f32 v41, v41
    v_smfmac_f32_32x32x32_bf16 v[104:119], v[144:147], v[32:39], v13
    s_mov_b64 exec, s[64:65]
    ds_read_b128 v[140:143], v15 offset:33792
    ds_read_b128 v[144:147], v15 offset:34304
    s_mov_b64 exec, -1
    v_mul_f32 v2, v2, v12
    v_pk_mul_f32 v[80:81], v[80:81], v[2:3] op_sel_hi:[1,0]
    v_pk_mul_f32 v[82:83], v[82:83], v[2:3] op_sel_hi:[1,0]
    v_pk_mul_f32 v[84:85], v[84:85], v[2:3] op_sel_hi:[1,0]
    v_pk_mul_f32 v[86:87], v[86:87], v[2:3] op_sel_hi:[1,0]
    v_cvt_pk_bf16_f32 v162, v80, v81
    v_cvt_pk_bf16_f32 v163, v82, v83
    v_cvt_pk_bf16_f32 v164, v84, v85
    v_cvt_pk_bf16_f32 v165, v86, v87
    v_min_u32 v162, -2, v162
    v_min_u32 v163, -2, v163
    v_min_u32 v164, -2, v164
    v_min_u32 v165, -2, v165
    buffer_store_dwordx4 v[162:165], v11, s[44:47], s27 offen sc1
    v_sub_f32 v12, 1.0, v12
    v_exp_f32 v42, v42
    v_exp_f32 v43, v43
    v_exp_f32 v44, v44
    v_exp_f32 v45, v45
    s_waitcnt lgkmcnt(2)
    v_mfma_f32_32x32x16_bf16 v[24:39], v[136:139], v[16:19], v[120:135]
    ds_read_b128 v[136:139], v14 offset:34816
    v_exp_f32 v46, v46
    v_exp_f32 v47, v47
    v_exp_f32 v48, v48
    v_exp_f32 v49, v49
    v_exp_f32 v50, v50
    v_smfmac_f32_32x32x32_bf16 v[104:119], v[148:151], v[40:47], v13
    v_exp_f32 v51, v51
    v_exp_f32 v52, v52
    v_exp_f32 v53, v53
    v_exp_f32 v54, v54
    v_exp_f32 v55, v55
    v_exp_f32 v24, v24
    v_exp_f32 v25, v25
    v_smfmac_f32_32x32x32_bf16 v[104:119], v[152:155], v[48:55], v13
    s_mov_b64 exec, s[64:65]
    ds_read_b128 v[148:151], v15 offset:35840
    ds_read_b128 v[152:155], v15 offset:36352
    s_mov_b64 exec, -1
    v_exp_f32 v26, v26
    v_exp_f32 v27, v27
    v_exp_f32 v28, v28
    v_exp_f32 v29, v29
    s_waitcnt lgkmcnt(2)
    v_mfma_f32_32x32x16_bf16 v[40:55], v[136:139], v[16:19], v[120:135]
    ds_read_b128 v[136:139], v14 offset:36864
L_arm:
    v_cmp_ne_u32 vcc, v157, v158
    s_cmp_eq_u32 vcc_lo, 0
    s_cbranch_scc0 L_armr
L_armk:
    v_exp_f32 v30, v30
    v_exp_f32 v31, v31
    v_exp_f32 v32, v32
    v_exp_f32 v33, v33
    v_exp_f32 v34, v34
    v_smfmac_f32_32x32x32_bf16 v[104:119], v[140:143], v[24:31], v13
    v_exp_f32 v35, v35
    v_exp_f32 v36, v36
    v_exp_f32 v37, v37
    v_exp_f32 v38, v38
    v_exp_f32 v39, v39
    v_exp_f32 v40, v40
    v_exp_f32 v41, v41
    v_smfmac_f32_32x32x32_bf16 v[104:119], v[144:147], v[32:39], v13
    s_mov_b64 exec, s[64:65]
    ds_read_b128 v[140:143], v15 offset:37888
    ds_read_b128 v[144:147], v15 offset:38400
    s_mov_b64 exec, -1
    v_exp_f32 v42, v42
    v_exp_f32 v43, v43
    v_exp_f32 v44, v44
    v_exp_f32 v45, v45
    s_waitcnt lgkmcnt(2)
    v_mfma_f32_32x32x16_bf16 v[24:39], v[136:139], v[16:19], v[120:135]
    ds_read_b128 v[136:139], v14 offset:38912
    v_exp_f32 v46, v46
    v_exp_f32 v47, v47
    v_exp_f32 v48, v48
    v_exp_f32 v49, v49
    v_exp_f32 v50, v50
    v_smfmac_f32_32x32x32_bf16 v[104:119], v[148:151], v[40:47], v13
    v_exp_f32 v51, v51
    v_exp_f32 v52, v52
    v_exp_f32 v53, v53
    v_exp_f32 v54, v54
    v_exp_f32 v55, v55
    v_exp_f32 v24, v24
    v_exp_f32 v25, v25
    v_smfmac_f32_32x32x32_bf16 v[104:119], v[152:155], v[48:55], v13
    s_mov_b64 exec, s[64:65]
    ds_read_b128 v[148:151], v15 offset:39936
    ds_read_b128 v[152:155], v15 offset:40448
    s_mov_b64 exec, -1
    s_setprio 2
    v_exp_f32 v26, v26
    v_exp_f32 v27, v27
    v_exp_f32 v28, v28
    v_exp_f32 v29, v29
    s_waitcnt lgkmcnt(2)
    v_mfma_f32_32x32x16_bf16 v[40:55], v[136:139], v[16:19], v[120:135]
    ds_read_b128 v[136:139], v14 offset:40960
    v_exp_f32 v30, v30
    v_exp_f32 v31, v31
    v_exp_f32 v32, v32
    v_exp_f32 v33, v33
    v_exp_f32 v34, v34
    v_smfmac_f32_32x32x32_bf16 v[104:119], v[140:143], v[24:31], v13
    v_exp_f32 v35, v35
    v_exp_f32 v36, v36
    v_exp_f32 v37, v37
    v_exp_f32 v38, v38
    v_exp_f32 v39, v39
    v_exp_f32 v40, v40
    v_exp_f32 v41, v41
    v_smfmac_f32_32x32x32_bf16 v[104:119], v[144:147], v[32:39], v13
    s_mov_b64 exec, s[64:65]
    ds_read_b128 v[140:143], v15 offset:41984
    ds_read_b128 v[144:147], v15 offset:42496
    s_mov_b64 exec, -1
    v_exp_f32 v42, v42
    v_exp_f32 v43, v43
    v_exp_f32 v44, v44
    v_exp_f32 v45, v45
    s_waitcnt lgkmcnt(2)
    v_mfma_f32_32x32x16_bf16 v[24:39], v[136:139], v[16:19], v[120:135]
    ds_read_b128 v[136:139], v14 offset:43008
    v_exp_f32 v46, v46
    v_exp_f32 v47, v47
    v_exp_f32 v48, v48
    v_exp_f32 v49, v49
    v_exp_f32 v50, v50
    v_smfmac_f32_32x32x32_bf16 v[104:119], v[148:151], v[40:47], v13
    v_exp_f32 v51, v51
    v_exp_f32 v52, v52
    v_exp_f32 v53, v53
    v_exp_f32 v54, v54
    v_exp_f32 v55, v55
    v_exp_f32 v24, v24
    v_exp_f32 v25, v25
    v_smfmac_f32_32x32x32_bf16 v[104:119], v[152:155], v[48:55], v13
    s_mov_b64 exec, s[64:65]
    ds_read_b128 v[148:151], v15 offset:44032
    ds_read_b128 v[152:155], v15 offset:44544
    s_mov_b64 exec, -1
    s_setprio 1
    v_exp_f32 v26, v26
    v_exp_f32 v27, v27
    v_exp_f32 v28, v28
    v_exp_f32 v29, v29
    s_waitcnt lgkmcnt(2)
    v_mfma_f32_32x32x16_bf16 v[40:55], v[136:139], v[16:19], v[120:135]
    ds_read_b128 v[136:139], v14 offset:45056
    v_exp_f32 v30, v30
    v_exp_f32 v31, v31
    v_exp_f32 v32, v32
    v_exp_f32 v33, v33
    v_exp_f32 v34, v34
    v_smfmac_f32_32x32x32_bf16 v[104:119], v[140:143], v[24:31], v13
    v_exp_f32 v35, v35
    v_exp_f32 v36, v36
    v_exp_f32 v37, v37
    v_exp_f32 v38, v38
    v_exp_f32 v39, v39
    v_exp_f32 v40, v40
    v_exp_f32 v41, v41
    v_smfmac_f32_32x32x32_bf16 v[104:119], v[144:147], v[32:39], v13
    s_mov_b64 exec, s[64:65]
    ds_read_b128 v[140:143], v15 offset:46080
    ds_read_b128 v[144:147], v15 offset:46592
    s_mov_b64 exec, -1
    s_setprio 0
    v_exp_f32 v42, v42
    v_exp_f32 v43, v43
    v_exp_f32 v44, v44
    v_exp_f32 v45, v45
    s_waitcnt lgkmcnt(2)
    v_mfma_f32_32x32x16_bf16 v[24:39], v[136:139], v[16:19], v[120:135]
    ds_read_b128 v[136:139], v14 offset:47104
    v_exp_f32 v46, v46
    v_exp_f32 v47, v47
    v_exp_f32 v48, v48
    v_exp_f32 v49, v49
    v_exp_f32 v50, v50
    v_smfmac_f32_32x32x32_bf16 v[104:119], v[148:151], v[40:47], v13
    v_exp_f32 v51, v51
    v_exp_f32 v52, v52
    v_exp_f32 v53, v53
    v_exp_f32 v54, v54
    v_exp_f32 v55, v55
    v_exp_f32 v24, v24
    v_exp_f32 v25, v25
    v_smfmac_f32_32x32x32_bf16 v[104:119], v[152:155], v[48:55], v13
    s_mov_b64 exec, s[64:65]
    ds_read_b128 v[148:151], v15 offset:48128
    ds_read_b128 v[152:155], v15 offset:48640
    s_mov_b64 exec, -1
    s_setprio 3
    v_exp_f32 v26, v26
    v_exp_f32 v27, v27
    v_exp_f32 v28, v28
    v_exp_f32 v29, v29
    s_waitcnt lgkmcnt(2)
    v_mfma_f32_32x32x16_bf16 v[40:55], v[136:139], v[16:19], v[120:135]
    ds_read_b128 v[136:139], v14 offset:49152
    buffer_load_dwordx4 v[56:59], v11, s[44:47], s57 offen offset:0 sc1
    v_exp_f32 v30, v30
    v_exp_f32 v31, v31
    v_exp_f32 v32, v32
    v_exp_f32 v33, v33
    v_exp_f32 v34, v34
    v_smfmac_f32_32x32x32_bf16 v[104:119], v[140:143], v[24:31], v13
    v_exp_f32 v35, v35
    v_exp_f32 v36, v36
    v_exp_f32 v37, v37
    v_exp_f32 v38, v38
    v_exp_f32 v39, v39
    v_exp_f32 v40, v40
    v_exp_f32 v41, v41
    v_smfmac_f32_32x32x32_bf16 v[104:119], v[144:147], v[32:39], v13
    s_mov_b64 exec, s[64:65]
    ds_read_b128 v[140:143], v15 offset:50176
    ds_read_b128 v[144:147], v15 offset:50688
    s_mov_b64 exec, -1
    v_exp_f32 v42, v42
    v_exp_f32 v43, v43
    v_exp_f32 v44, v44
    v_exp_f32 v45, v45
    s_waitcnt lgkmcnt(2)
    v_mfma_f32_32x32x16_bf16 v[24:39], v[136:139], v[16:19], v[120:135]
    ds_read_b128 v[136:139], v14 offset:51200
    buffer_load_dwordx4 v[60:63], v11, s[44:47], s57 offen offset:1024 sc1
    v_exp_f32 v46, v46
    v_exp_f32 v47, v47
    v_exp_f32 v48, v48
    v_exp_f32 v49, v49
    v_exp_f32 v50, v50
    v_smfmac_f32_32x32x32_bf16 v[104:119], v[148:151], v[40:47], v13
    v_exp_f32 v51, v51
    v_exp_f32 v52, v52
    v_exp_f32 v53, v53
    v_exp_f32 v54, v54
    v_exp_f32 v55, v55
    v_exp_f32 v24, v24
    v_exp_f32 v25, v25
    v_smfmac_f32_32x32x32_bf16 v[104:119], v[152:155], v[48:55], v13
    s_mov_b64 exec, s[64:65]
    ds_read_b128 v[148:151], v15 offset:52224
    ds_read_b128 v[152:155], v15 offset:52736
    s_mov_b64 exec, -1
    v_exp_f32 v26, v26
    v_exp_f32 v27, v27
    v_exp_f32 v28, v28
    v_exp_f32 v29, v29
    s_waitcnt lgkmcnt(2)
    v_mfma_f32_32x32x16_bf16 v[40:55], v[136:139], v[16:19], v[120:135]
    ds_read_b128 v[136:139], v14 offset:53248
    buffer_load_dwordx4 v[64:67], v11, s[44:47], s57 offen offset:2048 sc1
    v_exp_f32 v30, v30
    v_exp_f32 v31, v31
    v_exp_f32 v32, v32
    v_exp_f32 v33, v33
    v_exp_f32 v34, v34
    v_smfmac_f32_32x32x32_bf16 v[104:119], v[140:143], v[24:31], v13
    v_exp_f32 v35, v35
    v_exp_f32 v36, v36
    v_exp_f32 v37, v37
    v_exp_f32 v38, v38
    v_exp_f32 v39, v39
    v_exp_f32 v40, v40
    v_exp_f32 v41, v41
    v_smfmac_f32_32x32x32_bf16 v[104:119], v[144:147], v[32:39], v13
    s_mov_b64 exec, s[64:65]
    ds_read_b128 v[140:143], v15 offset:54272
    ds_read_b128 v[144:147], v15 offset:54784
    s_mov_b64 exec, -1
    v_exp_f32 v42, v42
    v_exp_f32 v43, v43
    v_exp_f32 v44, v44
    v_exp_f32 v45, v45
    s_waitcnt lgkmcnt(2)
    v_mfma_f32_32x32x16_bf16 v[24:39], v[136:139], v[16:19], v[120:135]
    ds_read_b128 v[136:139], v14 offset:55296
    buffer_load_dwordx4 v[68:71], v11, s[44:47], s57 offen offset:3072 sc1
    v_exp_f32 v46, v46
    v_exp_f32 v47, v47
    v_exp_f32 v48, v48
    v_exp_f32 v49, v49
    v_exp_f32 v50, v50
    v_smfmac_f32_32x32x32_bf16 v[104:119], v[148:151], v[40:47], v13
    v_exp_f32 v51, v51
    v_exp_f32 v52, v52
    v_exp_f32 v53, v53
    v_exp_f32 v54, v54
    v_exp_f32 v55, v55
    v_exp_f32 v24, v24
    v_exp_f32 v25, v25
    v_smfmac_f32_32x32x32_bf16 v[104:119], v[152:155], v[48:55], v13
    s_mov_b64 exec, s[64:65]
    ds_read_b128 v[148:151], v15 offset:56320
    ds_read_b128 v[152:155], v15 offset:56832
    s_mov_b64 exec, -1
    v_exp_f32 v26, v26
    v_exp_f32 v27, v27
    v_exp_f32 v28, v28
    v_exp_f32 v29, v29
    s_waitcnt lgkmcnt(2)
    v_mfma_f32_32x32x16_bf16 v[40:55], v[136:139], v[16:19], v[120:135]
    ds_read_b128 v[136:139], v14 offset:57344
    buffer_load_dwordx4 v[72:75], v11, s[44:47], s58 offen offset:0 sc1
    v_exp_f32 v30, v30
    v_exp_f32 v31, v31
    v_exp_f32 v32, v32
    v_exp_f32 v33, v33
    v_exp_f32 v34, v34
    v_smfmac_f32_32x32x32_bf16 v[104:119], v[140:143], v[24:31], v13
    v_exp_f32 v35, v35
    v_exp_f32 v36, v36
    v_exp_f32 v37, v37
    v_exp_f32 v38, v38
    v_exp_f32 v39, v39
    v_exp_f32 v40, v40
    v_exp_f32 v41, v41
    v_smfmac_f32_32x32x32_bf16 v[104:119], v[144:147], v[32:39], v13
    s_mov_b64 exec, s[64:65]
    ds_read_b128 v[140:143], v15 offset:58368
    ds_read_b128 v[144:147], v15 offset:58880
    s_mov_b64 exec, -1
    v_exp_f32 v42, v42
    v_exp_f32 v43, v43
    v_exp_f32 v44, v44
    v_exp_f32 v45, v45
    s_waitcnt lgkmcnt(2)
    v_mfma_f32_32x32x16_bf16 v[24:39], v[136:139], v[16:19], v[120:135]
    ds_read_b128 v[136:139], v14 offset:59392
    buffer_load_dwordx4 v[76:79], v11, s[44:47], s58 offen offset:1024 sc1
    v_exp_f32 v46, v46
    v_exp_f32 v47, v47
    v_exp_f32 v48, v48
    v_exp_f32 v49, v49
    v_exp_f32 v50, v50
    v_smfmac_f32_32x32x32_bf16 v[104:119], v[148:151], v[40:47], v13
    v_exp_f32 v51, v51
    v_exp_f32 v52, v52
    v_exp_f32 v53, v53
    v_exp_f32 v54, v54
    v_exp_f32 v55, v55
    v_exp_f32 v24, v24
    v_exp_f32 v25, v25
    v_smfmac_f32_32x32x32_bf16 v[104:119], v[152:155], v[48:55], v13
    s_mov_b64 exec, s[64:65]
    ds_read_b128 v[148:151], v15 offset:60416
    ds_read_b128 v[152:155], v15 offset:60928
    s_mov_b64 exec, -1
    s_setprio 2
    v_exp_f32 v26, v26
    v_exp_f32 v27, v27
    v_exp_f32 v28, v28
    v_exp_f32 v29, v29
    s_waitcnt lgkmcnt(2)
    v_mfma_f32_32x32x16_bf16 v[40:55], v[136:139], v[16:19], v[120:135]
    ds_read_b128 v[136:139], v14 offset:61440
    buffer_load_dwordx4 v[80:83], v11, s[44:47], s58 offen offset:2048 sc1
    v_exp_f32 v30, v30
    v_exp_f32 v31, v31
    v_exp_f32 v32, v32
    v_exp_f32 v33, v33
    v_exp_f32 v34, v34
    v_smfmac_f32_32x32x32_bf16 v[104:119], v[140:143], v[24:31], v13
    v_exp_f32 v35, v35
    v_exp_f32 v36, v36
    v_exp_f32 v37, v37
    v_exp_f32 v38, v38
    v_exp_f32 v39, v39
    v_exp_f32 v40, v40
    v_exp_f32 v41, v41
    v_smfmac_f32_32x32x32_bf16 v[104:119], v[144:147], v[32:39], v13
    s_mov_b64 exec, s[64:65]
    ds_read_b128 v[140:143], v15 offset:62464
    ds_read_b128 v[144:147], v15 offset:62976
    s_mov_b64 exec, -1
    v_exp_f32 v42, v42
    v_exp_f32 v43, v43
    v_exp_f32 v44, v44
    v_exp_f32 v45, v45
    s_waitcnt lgkmcnt(2)
    v_mfma_f32_32x32x16_bf16 v[24:39], v[136:139], v[16:19], v[120:135]
    ds_read_b128 v[136:139], v14 offset:63488
    buffer_load_dwordx4 v[84:87], v11, s[44:47], s58 offen offset:3072 sc1
    v_exp_f32 v46, v46
    v_exp_f32 v47, v47
    v_exp_f32 v48, v48
    v_exp_f32 v49, v49
    v_exp_f32 v50, v50
    v_smfmac_f32_32x32x32_bf16 v[104:119], v[148:151], v[40:47], v13
    v_exp_f32 v51, v51
    v_exp_f32 v52, v52
    v_exp_f32 v53, v53
    v_exp_f32 v54, v54
    v_exp_f32 v55, v55
    v_exp_f32 v24, v24
    v_exp_f32 v25, v25
    v_smfmac_f32_32x32x32_bf16 v[104:119], v[152:155], v[48:55], v13
    s_mov_b64 exec, s[64:65]
    ds_read_b128 v[148:151], v15 offset:64512
    ds_read_b128 v[152:155], v15 offset:65024
    s_mov_b64 exec, -1
    s_setprio 1
    v_exp_f32 v26, v26
    v_exp_f32 v27, v27
    v_exp_f32 v28, v28
    v_exp_f32 v29, v29
    s_waitcnt lgkmcnt(2)
    v_mfma_f32_32x32x16_bf16 v[40:55], v[136:139], v[16:19], v[120:135]
    s_nop 0
    v_exp_f32 v30, v30
    v_exp_f32 v31, v31
    v_exp_f32 v32, v32
    v_exp_f32 v33, v33
    v_exp_f32 v34, v34
    v_smfmac_f32_32x32x32_bf16 v[104:119], v[140:143], v[24:31], v13
    v_exp_f32 v35, v35
    v_exp_f32 v36, v36
    v_exp_f32 v37, v37
    v_exp_f32 v38, v38
    v_exp_f32 v39, v39
    v_exp_f32 v40, v40
    v_exp_f32 v41, v41
    v_smfmac_f32_32x32x32_bf16 v[104:119], v[144:147], v[32:39], v13
    s_setprio 0
    v_exp_f32 v42, v42
    v_exp_f32 v43, v43
    v_exp_f32 v44, v44
    v_exp_f32 v45, v45
    s_waitcnt lgkmcnt(0)
    v_exp_f32 v46, v46
    v_exp_f32 v47, v47
    v_exp_f32 v48, v48
    v_exp_f32 v49, v49
    v_exp_f32 v50, v50
    v_smfmac_f32_32x32x32_bf16 v[104:119], v[148:151], v[40:47], v13
    v_exp_f32 v51, v51
    v_exp_f32 v52, v52
    v_exp_f32 v53, v53
    v_exp_f32 v54, v54
    v_exp_f32 v55, v55
    s_nop 1
    v_smfmac_f32_32x32x32_bf16 v[104:119], v[152:155], v[48:55], v13
    ds_read_b64_tr_b16 v[88:89], v159 offset:0
    ds_read_b64_tr_b16 v[90:91], v159 offset:1024
    ds_read_b64_tr_b16 v[92:93], v160 offset:0
    ds_read_b64_tr_b16 v[94:95], v160 offset:1024
    ds_read_b64_tr_b16 v[96:97], v159 offset:2048
    ds_read_b64_tr_b16 v[98:99], v159 offset:3072
    ds_read_b64_tr_b16 v[100:101], v160 offset:2048
    ds_read_b64_tr_b16 v[102:103], v160 offset:3072
    s_mov_b32 s53, 0x5f800000
    s_nop 2
    v_rcp_f32 v2, v112
    v_cmp_nle_f32 vcc, v112, s53
    v_pk_mul_f32 v[4:5], v[104:105], 0
    v_pk_fma_f32 v[4:5], v[106:107], 0, v[4:5]
    v_pk_fma_f32 v[4:5], v[108:109], 0, v[4:5]
    v_pk_fma_f32 v[4:5], v[110:111], 0, v[4:5]
    v_cmp_u_f32 s[40:41], v4, v5
    s_or_b64 vcc, vcc, s[40:41]
    s_cbranch_vccnz L_fallback
L_norm:
    v_mul_f32 v2, v2, v12
    v_pk_mul_f32 v[104:105], v[104:105], v[2:3] op_sel_hi:[1,0]
    v_pk_mul_f32 v[106:107], v[106:107], v[2:3] op_sel_hi:[1,0]
    v_pk_mul_f32 v[108:109], v[108:109], v[2:3] op_sel_hi:[1,0]
    v_pk_mul_f32 v[110:111], v[110:111], v[2:3] op_sel_hi:[1,0]
    v_cvt_pk_bf16_f32 v162, v104, v105
    v_cvt_pk_bf16_f32 v163, v106, v107
    v_cvt_pk_bf16_f32 v164, v108, v109
    v_cvt_pk_bf16_f32 v165, v110, v111
    v_min_u32 v162, -2, v162
    v_min_u32 v163, -2, v163
    v_min_u32 v164, -2, v164
    v_min_u32 v165, -2, v165
    buffer_store_dwordx4 v[162:165], v11, s[44:47], s7 offen sc1
    ds_read_b64_tr_b16 v[104:105], v159 offset:4096
    ds_read_b64_tr_b16 v[106:107], v159 offset:5120
    ds_read_b64_tr_b16 v[108:109], v160 offset:4096
    ds_read_b64_tr_b16 v[110:111], v160 offset:5120
    s_mov_b32 s62, 0
    s_waitcnt vmcnt(1)
L_oa:
    v_max3_u32 v157, v56, v57, v58
    v_max3_u32 v157, v157, v59, v60
    v_max3_u32 v157, v157, v61, v62
    v_max3_u32 v157, v157, v63, v64
    v_max3_u32 v157, v157, v65, v66
    v_max3_u32 v157, v157, v67, v68
    v_max3_u32 v157, v157, v69, v70
    v_max3_u32 v157, v157, v71, v72
    v_max3_u32 v157, v157, v73, v74
    v_max3_u32 v157, v157, v75, v76
    v_max3_u32 v157, v157, v77, v78
    v_max3_u32 v157, v157, v79, v80
    v_max3_u32 v157, v157, v81, v82
    v_max3_u32 v157, v157, v83, v84
    v_max3_u32 v157, v157, v85, v86
    v_max_u32 v157, v157, v87
    v_cmp_eq_u32 vcc, -1, v157
    s_cbranch_vccnz L_oar
L_oak:
    s_waitcnt lgkmcnt(8)
    v_mfma_f32_32x32x16_bf16 v[24:39], v[88:91], v[56:59], 0
    v_mfma_f32_32x32x16_bf16 v[40:55], v[92:95], v[56:59], 0
    s_lshl_b32 s53, s52, 13
    s_sub_u32 s54, 131072, s53
    v_add_u32 v6, s54, v159
    v_add_u32 v7, s54, v160
    s_sub_u32 s54, 65536, s53
    v_add_u32 v20, s54, v159
    v_add_u32 v21, s54, v160
    v_and_b32 v2, 31, v1
    v_lshrrev_b32 v3, 5, v1
    ds_read_b64_tr_b16 v[112:113], v159 offset:6144
    ds_read_b64_tr_b16 v[114:115], v159 offset:7168
    ds_read_b64_tr_b16 v[116:117], v160 offset:6144
    ds_read_b64_tr_b16 v[118:119], v160 offset:7168
    s_waitcnt lgkmcnt(8)
    v_mfma_f32_32x32x16_bf16 v[24:39], v[96:99], v[60:63], v[24:39]
    v_mfma_f32_32x32x16_bf16 v[40:55], v[100:103], v[60:63], v[40:55]
    v_and_b32 v4, 7, v1
    v_xor_b32 v3, v3, v4
    v_lshlrev_b32 v3, 4, v3
    v_lshl_add_u32 v2, v2, 8, v3
    s_lshl_b32 s53, s52, 14
    s_lshl_b32 s54, s51, 13
    s_add_u32 s53, s53, s54
    v_add_u32 v2, s53, v2
    v_xor_b32 v3, 32, v2
    ds_read_b64_tr_b16 v[88:89], v159 offset:8192
    ds_read_b64_tr_b16 v[90:91], v159 offset:9216
    ds_read_b64_tr_b16 v[92:93], v160 offset:8192
    ds_read_b64_tr_b16 v[94:95], v160 offset:9216
    s_waitcnt lgkmcnt(8)
    v_mfma_f32_32x32x16_bf16 v[24:39], v[104:107], v[64:67], v[24:39]
    v_mfma_f32_32x32x16_bf16 v[40:55], v[108:111], v[64:67], v[40:55]
    v_xor_b32 v4, 64, v2
    v_xor_b32 v5, 96, v2
    v_lshrrev_b32 v8, 3, v1
    v_and_b32 v9, 7, v1
    v_lshlrev_b32 v10, 1, v9
    v_xor_b32 v10, v10, v8
    v_lshlrev_b32 v10, 4, v10
    v_lshl_add_u32 v10, v8, 8, v10
    s_lshl_b32 s53, s48, 11
    ds_read_b64_tr_b16 v[96:97], v159 offset:10240
    ds_read_b64_tr_b16 v[98:99], v159 offset:11264
    ds_read_b64_tr_b16 v[100:101], v160 offset:10240
    ds_read_b64_tr_b16 v[102:103], v160 offset:11264
    s_waitcnt lgkmcnt(8)
    v_mfma_f32_32x32x16_bf16 v[24:39], v[112:115], v[68:71], v[24:39]
    v_mfma_f32_32x32x16_bf16 v[40:55], v[116:119], v[68:71], v[40:55]
    v_add_u32 v10, s53, v10
    v_xor_b32 v14, 16, v10
    v_lshlrev_b32 v9, 4, v9
    v_lshl_add_u32 v8, v8, 10, v9
    s_lshl_b32 s7, s5, 16
    s_lshl_b32 s54, s48, 13
    s_add_u32 s7, s7, s54
    s_lshl_b32 s54, s6, 7
    s_add_u32 s7, s7, s54
    ds_read_b64_tr_b16 v[104:105], v159 offset:12288
    ds_read_b64_tr_b16 v[106:107], v159 offset:13312
    ds_read_b64_tr_b16 v[108:109], v160 offset:12288
    ds_read_b64_tr_b16 v[110:111], v160 offset:13312
    s_waitcnt lgkmcnt(8)
    v_mfma_f32_32x32x16_bf16 v[24:39], v[88:91], v[72:75], v[24:39]
    v_mfma_f32_32x32x16_bf16 v[40:55], v[92:95], v[72:75], v[40:55]
    ds_read_b64_tr_b16 v[112:113], v159 offset:14336
    ds_read_b64_tr_b16 v[114:115], v159 offset:15360
    ds_read_b64_tr_b16 v[116:117], v160 offset:14336
    ds_read_b64_tr_b16 v[118:119], v160 offset:15360
    s_waitcnt lgkmcnt(8)
    v_mfma_f32_32x32x16_bf16 v[24:39], v[96:99], v[76:79], v[24:39]
    v_mfma_f32_32x32x16_bf16 v[40:55], v[100:103], v[76:79], v[40:55]
    ds_read_b64_tr_b16 v[88:89], v6 offset:0
    ds_read_b64_tr_b16 v[90:91], v6 offset:1024
    ds_read_b64_tr_b16 v[92:93], v7 offset:0
    ds_read_b64_tr_b16 v[94:95], v7 offset:1024
    s_waitcnt lgkmcnt(8)
    v_mfma_f32_32x32x16_bf16 v[24:39], v[104:107], v[80:83], v[24:39]
    v_mfma_f32_32x32x16_bf16 v[40:55], v[108:111], v[80:83], v[40:55]
    ds_read_b64_tr_b16 v[96:97], v6 offset:2048
    ds_read_b64_tr_b16 v[98:99], v6 offset:3072
    ds_read_b64_tr_b16 v[100:101], v7 offset:2048
    ds_read_b64_tr_b16 v[102:103], v7 offset:3072
    s_waitcnt lgkmcnt(8)
    v_mfma_f32_32x32x16_bf16 v[24:39], v[112:115], v[84:87], v[24:39]
    v_mfma_f32_32x32x16_bf16 v[40:55], v[116:119], v[84:87], v[40:55]
    ds_read_b64_tr_b16 v[104:105], v6 offset:4096
    ds_read_b64_tr_b16 v[106:107], v6 offset:5120
    ds_read_b64_tr_b16 v[108:109], v7 offset:4096
    ds_read_b64_tr_b16 v[110:111], v7 offset:5120
    s_barrier
    buffer_load_dwordx4 v[120:123], v11, s[44:47], s59 offen offset:0 sc1
    buffer_load_dwordx4 v[124:127], v11, s[44:47], s59 offen offset:1024 sc1
    buffer_load_dwordx4 v[128:131], v11, s[44:47], s59 offen offset:2048 sc1
    buffer_load_dwordx4 v[132:135], v11, s[44:47], s59 offen offset:3072 sc1
    buffer_load_dwordx4 v[136:139], v11, s[44:47], s60 offen offset:0 sc1
    buffer_load_dwordx4 v[140:143], v11, s[44:47], s60 offen offset:1024 sc1
    buffer_load_dwordx4 v[144:147], v11, s[44:47], s60 offen offset:2048 sc1
    buffer_load_dwordx4 v[148:151], v11, s[44:47], s60 offen offset:3072 sc1
    s_waitcnt vmcnt(7)
L_ob0:
    v_max3_u32 v157, v120, v121, v122
    v_max_u32 v157, v157, v123
    v_cmp_eq_u32 vcc, -1, v157
    s_cbranch_vccnz L_obr0
L_obk0:
    s_waitcnt lgkmcnt(8)
    v_mfma_f32_32x32x16_bf16 v[24:39], v[88:91], v[120:123], v[24:39]
    v_mfma_f32_32x32x16_bf16 v[40:55], v[92:95], v[120:123], v[40:55]
    ds_read_b64_tr_b16 v[112:113], v6 offset:6144
    ds_read_b64_tr_b16 v[114:115], v6 offset:7168
    ds_read_b64_tr_b16 v[116:117], v7 offset:6144
    ds_read_b64_tr_b16 v[118:119], v7 offset:7168
    s_waitcnt vmcnt(6)
L_ob1:
    v_max3_u32 v157, v124, v125, v126
    v_max_u32 v157, v157, v127
    v_cmp_eq_u32 vcc, -1, v157
    s_cbranch_vccnz L_obr1
L_obk1:
    s_waitcnt lgkmcnt(8)
    v_mfma_f32_32x32x16_bf16 v[24:39], v[96:99], v[124:127], v[24:39]
    v_mfma_f32_32x32x16_bf16 v[40:55], v[100:103], v[124:127], v[40:55]
    s_waitcnt vmcnt(5)
L_ob2:
    v_max3_u32 v157, v128, v129, v130
    v_max_u32 v157, v157, v131
    v_cmp_eq_u32 vcc, -1, v157
    s_cbranch_vccnz L_obr2
L_obk2:
    s_waitcnt lgkmcnt(4)
    v_mfma_f32_32x32x16_bf16 v[24:39], v[104:107], v[128:131], v[24:39]
    v_mfma_f32_32x32x16_bf16 v[40:55], v[108:111], v[128:131], v[40:55]
    s_waitcnt vmcnt(4)
L_ob3:
    v_max3_u32 v157, v132, v133, v134
    v_max_u32 v157, v157, v135
    v_cmp_eq_u32 vcc, -1, v157
    s_cbranch_vccnz L_obr3
L_obk3:
    s_waitcnt lgkmcnt(0)
    v_mfma_f32_32x32x16_bf16 v[24:39], v[112:115], v[132:135], v[24:39]
    v_mfma_f32_32x32x16_bf16 v[40:55], v[116:119], v[132:135], v[40:55]
    ds_read_b64_tr_b16 v[88:89], v20 offset:0
    ds_read_b64_tr_b16 v[90:91], v20 offset:1024
    ds_read_b64_tr_b16 v[96:97], v20 offset:2048
    ds_read_b64_tr_b16 v[98:99], v20 offset:3072
    ds_read_b64_tr_b16 v[104:105], v20 offset:4096
    ds_read_b64_tr_b16 v[106:107], v20 offset:5120
    ds_read_b64_tr_b16 v[112:113], v20 offset:6144
    ds_read_b64_tr_b16 v[114:115], v20 offset:7168
    ds_read_b64_tr_b16 v[92:93], v21 offset:0
    ds_read_b64_tr_b16 v[94:95], v21 offset:1024
    ds_read_b64_tr_b16 v[100:101], v21 offset:2048
    ds_read_b64_tr_b16 v[102:103], v21 offset:3072
    ds_read_b64_tr_b16 v[108:109], v21 offset:4096
    ds_read_b64_tr_b16 v[110:111], v21 offset:5120
    s_waitcnt vmcnt(3)
L_ob4:
    v_max3_u32 v157, v136, v137, v138
    v_max_u32 v157, v157, v139
    v_cmp_eq_u32 vcc, -1, v157
    s_cbranch_vccnz L_obr4
L_obk4:
    s_waitcnt lgkmcnt(12)
    v_mfma_f32_32x32x16_bf16 v[24:39], v[88:91], v[136:139], v[24:39]
    ds_read_b64_tr_b16 v[116:117], v21 offset:6144
    ds_read_b64_tr_b16 v[118:119], v21 offset:7168
    s_waitcnt vmcnt(2)
L_ob5:
    v_max3_u32 v157, v140, v141, v142
    v_max_u32 v157, v157, v143
    v_cmp_eq_u32 vcc, -1, v157
    s_cbranch_vccnz L_obr5
L_obk5:
    s_waitcnt lgkmcnt(12)
    v_mfma_f32_32x32x16_bf16 v[24:39], v[96:99], v[140:143], v[24:39]
    s_waitcnt vmcnt(1)
L_ob6:
    v_max3_u32 v157, v144, v145, v146
    v_max_u32 v157, v157, v147
    v_cmp_eq_u32 vcc, -1, v157
    s_cbranch_vccnz L_obr6
L_obk6:
    s_waitcnt lgkmcnt(10)
    v_mfma_f32_32x32x16_bf16 v[24:39], v[104:107], v[144:147], v[24:39]
    s_waitcnt vmcnt(0)
L_ob7:
    v_max3_u32 v157, v148, v149, v150
    v_max_u32 v157, v157, v151
    v_cmp_eq_u32 vcc, -1, v157
    s_cbranch_vccnz L_obr7
L_obk7:
    s_waitcnt lgkmcnt(8)
    v_mfma_f32_32x32x16_bf16 v[24:39], v[112:115], v[148:151], v[24:39]
    s_waitcnt lgkmcnt(6)
    v_mfma_f32_32x32x16_bf16 v[40:55], v[92:95], v[136:139], v[40:55]
    s_waitcnt lgkmcnt(4)
    v_mfma_f32_32x32x16_bf16 v[40:55], v[100:103], v[140:143], v[40:55]
    s_waitcnt lgkmcnt(2)
    v_mfma_f32_32x32x16_bf16 v[40:55], v[108:111], v[144:147], v[40:55]
    s_waitcnt lgkmcnt(0)
    v_mfma_f32_32x32x16_bf16 v[40:55], v[116:119], v[148:151], v[40:55]
    s_nop 3
    ds_write_b128 v2, v[24:27] offset:0
    ds_write_b128 v3, v[28:31] offset:0
    ds_write_b128 v4, v[32:35] offset:0
    ds_write_b128 v5, v[36:39] offset:0
    s_nop 3
    ds_write_b128 v2, v[40:43] offset:128
    ds_write_b128 v3, v[44:47] offset:128
    ds_write_b128 v4, v[48:51] offset:128
    ds_write_b128 v5, v[52:55] offset:128
    s_waitcnt lgkmcnt(0)
    s_barrier
    ds_read_b128 v[56:59], v10 offset:0
    ds_read_b128 v[60:63], v14 offset:0
    ds_read_b128 v[64:67], v10 offset:16384
    ds_read_b128 v[68:71], v14 offset:16384
    ds_read_b128 v[72:75], v10 offset:32768
    ds_read_b128 v[76:79], v14 offset:32768
    ds_read_b128 v[80:83], v10 offset:49152
    ds_read_b128 v[84:87], v14 offset:49152
    s_waitcnt lgkmcnt(4)
    v_pk_add_f32 v[56:57], v[56:57], v[64:65]
    v_pk_add_f32 v[58:59], v[58:59], v[66:67]
    v_pk_add_f32 v[60:61], v[60:61], v[68:69]
    v_pk_add_f32 v[62:63], v[62:63], v[70:71]
    s_waitcnt lgkmcnt(2)
    v_pk_add_f32 v[56:57], v[56:57], v[72:73]
    v_pk_add_f32 v[58:59], v[58:59], v[74:75]
    v_pk_add_f32 v[60:61], v[60:61], v[76:77]
    v_pk_add_f32 v[62:63], v[62:63], v[78:79]
    s_waitcnt lgkmcnt(0)
    v_pk_add_f32 v[56:57], v[56:57], v[80:81]
    v_pk_add_f32 v[58:59], v[58:59], v[82:83]
    v_pk_add_f32 v[60:61], v[60:61], v[84:85]
    v_pk_add_f32 v[62:63], v[62:63], v[86:87]
    v_cvt_pk_bf16_f32 v64, v56, v57
    v_cvt_pk_bf16_f32 v65, v58, v59
    v_cvt_pk_bf16_f32 v66, v60, v61
    v_cvt_pk_bf16_f32 v67, v62, v63
    buffer_store_dwordx4 v[64:67], v8, s[36:39], s7 offen
L_end:
    s_endpgm
L_armr:
    s_add_u32 s62, s62, 1
    s_cmp_ge_u32 s62, 100000
    s_cbranch_scc1 L_armk
    s_mov_b32 exec_hi, 0
    buffer_load_dword v157, v156, s[44:47], s30 offen sc1
    s_mov_b32 exec_hi, -1
    s_waitcnt vmcnt(0)
    s_branch L_arm
L_oar:
    s_add_u32 s62, s62, 1
    s_cmp_ge_u32 s62, 100000
    s_cbranch_scc1 L_oak
    buffer_load_dwordx4 v[56:59], v11, s[44:47], s57 offen offset:0 sc1
    buffer_load_dwordx4 v[60:63], v11, s[44:47], s57 offen offset:1024 sc1
    buffer_load_dwordx4 v[64:67], v11, s[44:47], s57 offen offset:2048 sc1
    buffer_load_dwordx4 v[68:71], v11, s[44:47], s57 offen offset:3072 sc1
    buffer_load_dwordx4 v[72:75], v11, s[44:47], s58 offen offset:0 sc1
    buffer_load_dwordx4 v[76:79], v11, s[44:47], s58 offen offset:1024 sc1
    buffer_load_dwordx4 v[80:83], v11, s[44:47], s58 offen offset:2048 sc1
    buffer_load_dwordx4 v[84:87], v11, s[44:47], s58 offen offset:3072 sc1
    s_waitcnt vmcnt(0)
    s_branch L_oa
L_obr0:
    s_add_u32 s62, s62, 1
    s_cmp_ge_u32 s62, 100000
    s_cbranch_scc1 L_obk0
    buffer_load_dwordx4 v[120:123], v11, s[44:47], s59 offen offset:0 sc1
    buffer_load_dwordx4 v[124:127], v11, s[44:47], s59 offen offset:1024 sc1
    buffer_load_dwordx4 v[128:131], v11, s[44:47], s59 offen offset:2048 sc1
    buffer_load_dwordx4 v[132:135], v11, s[44:47], s59 offen offset:3072 sc1
    buffer_load_dwordx4 v[136:139], v11, s[44:47], s60 offen offset:0 sc1
    buffer_load_dwordx4 v[140:143], v11, s[44:47], s60 offen offset:1024 sc1
    buffer_load_dwordx4 v[144:147], v11, s[44:47], s60 offen offset:2048 sc1
    buffer_load_dwordx4 v[148:151], v11, s[44:47], s60 offen offset:3072 sc1
    s_waitcnt vmcnt(7)
    s_branch L_ob0
L_obr1:
    s_add_u32 s62, s62, 1
    s_cmp_ge_u32 s62, 100000
    s_cbranch_scc1 L_obk1
    buffer_load_dwordx4 v[124:127], v11, s[44:47], s59 offen offset:1024 sc1
    buffer_load_dwordx4 v[128:131], v11, s[44:47], s59 offen offset:2048 sc1
    buffer_load_dwordx4 v[132:135], v11, s[44:47], s59 offen offset:3072 sc1
    buffer_load_dwordx4 v[136:139], v11, s[44:47], s60 offen offset:0 sc1
    buffer_load_dwordx4 v[140:143], v11, s[44:47], s60 offen offset:1024 sc1
    buffer_load_dwordx4 v[144:147], v11, s[44:47], s60 offen offset:2048 sc1
    buffer_load_dwordx4 v[148:151], v11, s[44:47], s60 offen offset:3072 sc1
    s_waitcnt vmcnt(6)
    s_branch L_ob1
L_obr2:
    s_add_u32 s62, s62, 1
    s_cmp_ge_u32 s62, 100000
    s_cbranch_scc1 L_obk2
    buffer_load_dwordx4 v[128:131], v11, s[44:47], s59 offen offset:2048 sc1
    buffer_load_dwordx4 v[132:135], v11, s[44:47], s59 offen offset:3072 sc1
    buffer_load_dwordx4 v[136:139], v11, s[44:47], s60 offen offset:0 sc1
    buffer_load_dwordx4 v[140:143], v11, s[44:47], s60 offen offset:1024 sc1
    buffer_load_dwordx4 v[144:147], v11, s[44:47], s60 offen offset:2048 sc1
    buffer_load_dwordx4 v[148:151], v11, s[44:47], s60 offen offset:3072 sc1
    s_waitcnt vmcnt(5)
    s_branch L_ob2
L_obr3:
    s_add_u32 s62, s62, 1
    s_cmp_ge_u32 s62, 100000
    s_cbranch_scc1 L_obk3
    buffer_load_dwordx4 v[132:135], v11, s[44:47], s59 offen offset:3072 sc1
    buffer_load_dwordx4 v[136:139], v11, s[44:47], s60 offen offset:0 sc1
    buffer_load_dwordx4 v[140:143], v11, s[44:47], s60 offen offset:1024 sc1
    buffer_load_dwordx4 v[144:147], v11, s[44:47], s60 offen offset:2048 sc1
    buffer_load_dwordx4 v[148:151], v11, s[44:47], s60 offen offset:3072 sc1
    s_waitcnt vmcnt(4)
    s_branch L_ob3
L_obr4:
    s_add_u32 s62, s62, 1
    s_cmp_ge_u32 s62, 100000
    s_cbranch_scc1 L_obk4
    buffer_load_dwordx4 v[136:139], v11, s[44:47], s60 offen offset:0 sc1
    buffer_load_dwordx4 v[140:143], v11, s[44:47], s60 offen offset:1024 sc1
    buffer_load_dwordx4 v[144:147], v11, s[44:47], s60 offen offset:2048 sc1
    buffer_load_dwordx4 v[148:151], v11, s[44:47], s60 offen offset:3072 sc1
    s_waitcnt vmcnt(3)
    s_branch L_ob4
L_obr5:
    s_add_u32 s62, s62, 1
    s_cmp_ge_u32 s62, 100000
    s_cbranch_scc1 L_obk5
    buffer_load_dwordx4 v[140:143], v11, s[44:47], s60 offen offset:1024 sc1
    buffer_load_dwordx4 v[144:147], v11, s[44:47], s60 offen offset:2048 sc1
    buffer_load_dwordx4 v[148:151], v11, s[44:47], s60 offen offset:3072 sc1
    s_waitcnt vmcnt(2)
    s_branch L_ob5
L_obr6:
    s_add_u32 s62, s62, 1
    s_cmp_ge_u32 s62, 100000
    s_cbranch_scc1 L_obk6
    buffer_load_dwordx4 v[144:147], v11, s[44:47], s60 offen offset:2048 sc1
    buffer_load_dwordx4 v[148:151], v11, s[44:47], s60 offen offset:3072 sc1
    s_waitcnt vmcnt(1)
    s_branch L_ob6
L_obr7:
    s_add_u32 s62, s62, 1
    s_cmp_ge_u32 s62, 100000
    s_cbranch_scc1 L_obk7
    buffer_load_dwordx4 v[148:151], v11, s[44:47], s60 offen offset:3072 sc1
    s_waitcnt vmcnt(0)
    s_branch L_ob7
L_fallback:
    v_mov_b32 v2, 0xff800000
    s_mov_b32 s53, 131072
L_fb1:
    buffer_load_dwordx4 v[136:139], v11, s[44:47], s53 offen sc1
    s_waitcnt vmcnt(0)
    v_mfma_f32_32x32x16_bf16 v[24:39], v[136:139], v[16:19], 0
    s_nop 15
    v_max3_f32 v2, v2, v24, v25
    v_max3_f32 v2, v2, v26, v27
    v_max3_f32 v2, v2, v28, v29
    v_max3_f32 v2, v2, v30, v31
    v_max3_f32 v2, v2, v32, v33
    v_max3_f32 v2, v2, v34, v35
    v_max3_f32 v2, v2, v36, v37
    v_max3_f32 v2, v2, v38, v39
    s_add_u32 s53, s53, 2048
    s_cmp_lt_u32 s53, 262144
    s_cbranch_scc1 L_fb1
    v_mov_b32 v3, v2
    s_nop 1
    v_permlane32_swap_b32 v2, v3
    s_nop 1
    v_max_f32 v2, v2, v3
    v_sub_f32 v120, 0, v2
    v_mov_b32 v104, 0
    v_sub_f32 v121, 0, v2
    v_mov_b32 v105, 0
    v_sub_f32 v122, 0, v2
    v_mov_b32 v106, 0
    v_sub_f32 v123, 0, v2
    v_mov_b32 v107, 0
    v_sub_f32 v124, 0, v2
    v_mov_b32 v108, 0
    v_sub_f32 v125, 0, v2
    v_mov_b32 v109, 0
    v_sub_f32 v126, 0, v2
    v_mov_b32 v110, 0
    v_sub_f32 v127, 0, v2
    v_mov_b32 v111, 0
    v_sub_f32 v128, 0, v2
    v_mov_b32 v112, 0
    v_sub_f32 v129, 0, v2
    v_mov_b32 v113, 0
    v_sub_f32 v130, 0, v2
    v_mov_b32 v114, 0
    v_sub_f32 v131, 0, v2
    v_mov_b32 v115, 0
    v_sub_f32 v132, 0, v2
    v_mov_b32 v116, 0
    v_sub_f32 v133, 0, v2
    v_mov_b32 v117, 0
    v_sub_f32 v134, 0, v2
    v_mov_b32 v118, 0
    v_sub_f32 v135, 0, v2
    v_mov_b32 v119, 0
    v_and_b32 v15, 0x3ff, v15
    s_mov_b32 s53, 131072
L_fb2:
    buffer_load_dwordx4 v[136:139], v11, s[44:47], s53 offen sc1
    s_mov_b64 exec, s[64:65]
    buffer_load_dwordx4 v[140:143], v15, s[44:47], s53 offen offset:1024 sc1
    buffer_load_dwordx4 v[144:147], v15, s[44:47], s53 offen offset:1536 sc1
    s_mov_b64 exec, -1
    s_waitcnt vmcnt(0)
    v_mfma_f32_32x32x16_bf16 v[24:39], v[136:139], v[16:19], v[120:135]
    s_nop 15
    v_exp_f32 v24, v24
    v_exp_f32 v25, v25
    v_exp_f32 v26, v26
    v_exp_f32 v27, v27
    v_exp_f32 v28, v28
    v_exp_f32 v29, v29
    v_exp_f32 v30, v30
    v_exp_f32 v31, v31
    v_exp_f32 v32, v32
    v_exp_f32 v33, v33
    v_exp_f32 v34, v34
    v_exp_f32 v35, v35
    v_exp_f32 v36, v36
    v_exp_f32 v37, v37
    v_exp_f32 v38, v38
    v_exp_f32 v39, v39
    s_nop 1
    v_smfmac_f32_32x32x32_bf16 v[104:119], v[140:143], v[24:31], v13
    v_smfmac_f32_32x32x32_bf16 v[104:119], v[144:147], v[32:39], v13
    s_add_u32 s53, s53, 2048
    s_cmp_lt_u32 s53, 262144
    s_cbranch_scc1 L_fb2
    s_nop 15
    v_rcp_f32 v2, v112
    s_nop 0
    s_branch L_norm
L_a0:
    s_setprio 3
    s_lshl_b32 s54, s22, 14
    s_add_u32 s57, s53, s54
    s_lshl_b32 s54, s22, 10
    s_add_u32 s58, s54, 65536
    s_mov_b32 s18, 16384
    s_mov_b32 s19, 0x20000
    s_bitcmp1_b32 s50, 0
    s_waitcnt lgkmcnt(0)
    s_mov_b32 s8, s76
    s_mov_b32 s9, s77
    s_cselect_b32 s16, s88, s86
    s_cselect_b32 s17, s89, s87
    s_load_dword s4, s[98:99], 0
    s_lshl_b32 s59, s69, 11
    s_lshl_b32 s54, s69, 7
    v_xor_b32 v2, s54, v11
    s_add_u32 m0, s58, 0
    s_xor_b32 s54, s57, 0
    buffer_load_dwordx4 v6, s[8:11], s54 offen offset:0 lds
    s_add_u32 m0, s58, 4032
    s_nop 0
    buffer_load_dwordx4 v6, s[8:11], s54 offen offset:64 lds
    s_add_u32 m0, s58, 8192
    s_xor_b32 s54, s57, 128
    buffer_load_dwordx4 v6, s[8:11], s54 offen offset:0 lds
    s_add_u32 m0, s58, 12224
    s_nop 0
    buffer_load_dwordx4 v6, s[8:11], s54 offen offset:64 lds
    s_mov_b32 m0, 0
    s_xor_b32 s55, s59, 0
    buffer_load_dwordx4 v11, s[16:19], s55 offen offset:0 lds
    buffer_load_dwordx4 v11, s[16:19], s55 offen offset:1024 lds
    s_mov_b32 m0, 2048
    s_xor_b32 s55, s59, 2048
    buffer_load_dwordx4 v11, s[16:19], s55 offen offset:0 lds
    buffer_load_dwordx4 v11, s[16:19], s55 offen offset:1024 lds
    s_mov_b32 s12, s92
    s_mov_b32 s13, s93
    s_mov_b32 s14, 0x400
    s_mov_b32 s15, 0x20000
    s_mov_b32 m0, 147456
    s_nop 0
    buffer_load_dwordx4 v2, s[12:15], 0 offen lds
    s_add_u32 m0, s58, 16384
    s_xor_b32 s54, s57, 256
    buffer_load_dwordx4 v6, s[8:11], s54 offen offset:0 lds
    s_add_u32 m0, s58, 20416
    s_nop 0
    buffer_load_dwordx4 v6, s[8:11], s54 offen offset:64 lds
    s_add_u32 m0, s58, 24576
    s_xor_b32 s54, s57, 384
    buffer_load_dwordx4 v6, s[8:11], s54 offen offset:0 lds
    s_add_u32 m0, s58, 28608
    s_nop 0
    buffer_load_dwordx4 v6, s[8:11], s54 offen offset:64 lds
    s_mov_b32 m0, 4096
    s_xor_b32 s55, s59, 4096
    buffer_load_dwordx4 v11, s[16:19], s55 offen offset:0 lds
    buffer_load_dwordx4 v11, s[16:19], s55 offen offset:1024 lds
    s_mov_b32 m0, 6144
    s_xor_b32 s55, s59, 6144
    buffer_load_dwordx4 v11, s[16:19], s55 offen offset:0 lds
    buffer_load_dwordx4 v11, s[16:19], s55 offen offset:1024 lds
    s_add_u32 m0, s58, 32768
    s_xor_b32 s54, s57, 512
    buffer_load_dwordx4 v6, s[8:11], s54 offen offset:0 lds
    s_add_u32 m0, s58, 36800
    s_nop 0
    buffer_load_dwordx4 v6, s[8:11], s54 offen offset:64 lds
    s_add_u32 m0, s58, 40960
    s_xor_b32 s54, s57, 640
    buffer_load_dwordx4 v6, s[8:11], s54 offen offset:0 lds
    s_add_u32 m0, s58, 44992
    s_nop 0
    buffer_load_dwordx4 v6, s[8:11], s54 offen offset:64 lds
    s_mov_b32 m0, 8192
    s_xor_b32 s55, s59, 8192
    buffer_load_dwordx4 v11, s[16:19], s55 offen offset:0 lds
    buffer_load_dwordx4 v11, s[16:19], s55 offen offset:1024 lds
    s_mov_b32 m0, 10240
    s_xor_b32 s55, s59, 10240
    buffer_load_dwordx4 v11, s[16:19], s55 offen offset:0 lds
    buffer_load_dwordx4 v11, s[16:19], s55 offen offset:1024 lds
    s_add_u32 m0, s58, 49152
    s_xor_b32 s54, s57, 768
    buffer_load_dwordx4 v6, s[8:11], s54 offen offset:0 lds
    s_add_u32 m0, s58, 53184
    s_nop 0
    buffer_load_dwordx4 v6, s[8:11], s54 offen offset:64 lds
    s_add_u32 m0, s58, 57344
    s_xor_b32 s54, s57, 896
    buffer_load_dwordx4 v6, s[8:11], s54 offen offset:0 lds
    s_add_u32 m0, s58, 61376
    s_nop 0
    buffer_load_dwordx4 v6, s[8:11], s54 offen offset:64 lds
    s_mov_b32 m0, 12288
    s_xor_b32 s55, s59, 12288
    buffer_load_dwordx4 v11, s[16:19], s55 offen offset:0 lds
    buffer_load_dwordx4 v11, s[16:19], s55 offen offset:1024 lds
    s_mov_b32 m0, 14336
    s_xor_b32 s55, s59, 14336
    buffer_load_dwordx4 v11, s[16:19], s55 offen offset:0 lds
    buffer_load_dwordx4 v11, s[16:19], s55 offen offset:1024 lds
    s_mov_b32 s44, s98
    s_mov_b32 s45, s99
    s_mov_b32 s46, 0x1000000
    s_mov_b32 s47, 0x20000
    s_and_b32 s63, s2, 7
    s_lshl_b32 s63, s63, 3
    v_and_b32 v2, 15, v1
    v_lshrrev_b32 v3, 4, v1
    v_bfe_u32 v4, v1, 2, 2
    v_xor_b32 v4, v4, v3
    v_lshlrev_b32 v4, 4, v4
    v_lshl_add_u32 v4, v2, 6, v4
    v_add_u32 v4, s58, v4
    v_lshlrev_b32 v5, 3, v2
    v_lshl_add_u32 v5, v3, 8, v5
    v_lshlrev_b32 v8, 4, v3
    v_add_u32 v8, 147456, v8
    v_lshlrev_b32 v13, 4, v2
    v_and_b32 v14, 1, v3
    v_lshrrev_b32 v15, 1, v3
    s_lshl_b32 s53, s49, 1
    s_lshr_b32 s54, s22, 1
    s_add_u32 s61, s53, s54
    s_lshl_b32 s56, s61, 4
    s_and_b32 s53, s50, 3
    s_lshl_b32 s53, s53, 2
    s_add_u32 s56, s56, s53
    s_add_u32 s56, s56, 1024
    s_waitcnt lgkmcnt(0)
    s_mul_i32 s4, s4, 0x9e3779b1
    s_add_u32 s4, s4, 0x7f4a7c15
    v_mov_b32 v158, s4
    s_bitcmp1_b32 s50, 0
    s_cbranch_scc1 L_jobV
    s_waitcnt vmcnt(25)
    s_barrier
    s_waitcnt vmcnt(16)
    ds_read_b128 v[16:19], v4 offset:0
    ds_read_b64_tr_b16 v[48:49], v5 offset:0
    ds_read_b64_tr_b16 v[50:51], v5 offset:128
    ds_read_b128 v[80:83], v8 offset:0
    ds_read_b128 v[20:23], v4 offset:4096
    ds_read_b64_tr_b16 v[52:53], v5 offset:1024
    ds_read_b64_tr_b16 v[54:55], v5 offset:1152
    ds_read_b128 v[84:87], v8 offset:64
    ds_read_b128 v[24:27], v4 offset:8192
    ds_read_b64_tr_b16 v[56:57], v5 offset:2048
    ds_read_b64_tr_b16 v[58:59], v5 offset:2176
    ds_read_b128 v[88:91], v8 offset:128
    s_waitcnt lgkmcnt(8)
    v_mfma_f32_16x16x32_bf16 v[144:147], v[48:51], v[16:19], 0
    v_mfma_f32_16x16x32_bf16 v[112:115], v[80:83], v[16:19], 0
    ds_read_b128 v[28:31], v4 offset:12288
    ds_read_b64_tr_b16 v[60:61], v5 offset:3072
    ds_read_b64_tr_b16 v[62:63], v5 offset:3200
    ds_read_b128 v[92:95], v8 offset:192
    s_waitcnt lgkmcnt(8)
    v_mfma_f32_16x16x32_bf16 v[144:147], v[52:55], v[20:23], v[144:147]
    v_mfma_f32_16x16x32_bf16 v[112:115], v[84:87], v[20:23], v[112:115]
    ds_read_b128 v[32:35], v4 offset:16384
    ds_read_b64_tr_b16 v[64:65], v5 offset:4096
    ds_read_b64_tr_b16 v[66:67], v5 offset:4224
    ds_read_b128 v[96:99], v8 offset:256
    s_waitcnt lgkmcnt(8)
    v_mfma_f32_16x16x32_bf16 v[144:147], v[56:59], v[24:27], v[144:147]
    v_mfma_f32_16x16x32_bf16 v[112:115], v[88:91], v[24:27], v[112:115]
    ds_read_b128 v[36:39], v4 offset:20480
    ds_read_b64_tr_b16 v[68:69], v5 offset:5120
    ds_read_b64_tr_b16 v[70:71], v5 offset:5248
    ds_read_b128 v[100:103], v8 offset:320
    s_waitcnt lgkmcnt(8)
    v_mfma_f32_16x16x32_bf16 v[144:147], v[60:63], v[28:31], v[144:147]
    v_mfma_f32_16x16x32_bf16 v[112:115], v[92:95], v[28:31], v[112:115]
    ds_read_b128 v[40:43], v4 offset:24576
    ds_read_b64_tr_b16 v[72:73], v5 offset:6144
    ds_read_b64_tr_b16 v[74:75], v5 offset:6272
    ds_read_b128 v[104:107], v8 offset:384
    s_waitcnt lgkmcnt(8)
    v_mfma_f32_16x16x32_bf16 v[144:147], v[64:67], v[32:35], v[144:147]
    v_mfma_f32_16x16x32_bf16 v[112:115], v[96:99], v[32:35], v[112:115]
    ds_read_b128 v[44:47], v4 offset:28672
    ds_read_b64_tr_b16 v[76:77], v5 offset:7168
    ds_read_b64_tr_b16 v[78:79], v5 offset:7296
    ds_read_b128 v[108:111], v8 offset:448
    s_waitcnt lgkmcnt(8)
    v_mfma_f32_16x16x32_bf16 v[144:147], v[68:71], v[36:39], v[144:147]
    v_mfma_f32_16x16x32_bf16 v[112:115], v[100:103], v[36:39], v[112:115]
    s_waitcnt lgkmcnt(4)
    v_mfma_f32_16x16x32_bf16 v[144:147], v[72:75], v[40:43], v[144:147]
    v_mfma_f32_16x16x32_bf16 v[112:115], v[104:107], v[40:43], v[112:115]
    s_waitcnt lgkmcnt(0)
    v_mfma_f32_16x16x32_bf16 v[144:147], v[76:79], v[44:47], v[144:147]
    v_mfma_f32_16x16x32_bf16 v[112:115], v[108:111], v[44:47], v[112:115]
    s_waitcnt vmcnt(8)
    s_barrier
    s_waitcnt vmcnt(0)
    ds_read_b128 v[16:19], v4 offset:32768
    ds_read_b64_tr_b16 v[48:49], v5 offset:8192
    ds_read_b64_tr_b16 v[50:51], v5 offset:8320
    ds_read_b128 v[80:83], v8 offset:512
    ds_read_b128 v[20:23], v4 offset:36864
    ds_read_b64_tr_b16 v[52:53], v5 offset:9216
    ds_read_b64_tr_b16 v[54:55], v5 offset:9344
    ds_read_b128 v[84:87], v8 offset:576
    ds_read_b128 v[24:27], v4 offset:40960
    ds_read_b64_tr_b16 v[56:57], v5 offset:10240
    ds_read_b64_tr_b16 v[58:59], v5 offset:10368
    ds_read_b128 v[88:91], v8 offset:640
    s_waitcnt lgkmcnt(8)
    v_mfma_f32_16x16x32_bf16 v[144:147], v[48:51], v[16:19], v[144:147]
    v_mfma_f32_16x16x32_bf16 v[112:115], v[80:83], v[16:19], v[112:115]
    ds_read_b128 v[28:31], v4 offset:45056
    ds_read_b64_tr_b16 v[60:61], v5 offset:11264
    ds_read_b64_tr_b16 v[62:63], v5 offset:11392
    ds_read_b128 v[92:95], v8 offset:704
    s_waitcnt lgkmcnt(8)
    v_mfma_f32_16x16x32_bf16 v[144:147], v[52:55], v[20:23], v[144:147]
    v_mfma_f32_16x16x32_bf16 v[112:115], v[84:87], v[20:23], v[112:115]
    ds_read_b128 v[32:35], v4 offset:49152
    ds_read_b64_tr_b16 v[64:65], v5 offset:12288
    ds_read_b64_tr_b16 v[66:67], v5 offset:12416
    ds_read_b128 v[96:99], v8 offset:768
    s_waitcnt lgkmcnt(8)
    v_mfma_f32_16x16x32_bf16 v[144:147], v[56:59], v[24:27], v[144:147]
    v_mfma_f32_16x16x32_bf16 v[112:115], v[88:91], v[24:27], v[112:115]
    ds_read_b128 v[36:39], v4 offset:53248
    ds_read_b64_tr_b16 v[68:69], v5 offset:13312
    ds_read_b64_tr_b16 v[70:71], v5 offset:13440
    ds_read_b128 v[100:103], v8 offset:832
    s_waitcnt lgkmcnt(8)
    v_mfma_f32_16x16x32_bf16 v[144:147], v[60:63], v[28:31], v[144:147]
    v_mfma_f32_16x16x32_bf16 v[112:115], v[92:95], v[28:31], v[112:115]
    ds_read_b128 v[40:43], v4 offset:57344
    ds_read_b64_tr_b16 v[72:73], v5 offset:14336
    ds_read_b64_tr_b16 v[74:75], v5 offset:14464
    ds_read_b128 v[104:107], v8 offset:896
    s_waitcnt lgkmcnt(8)
    v_mfma_f32_16x16x32_bf16 v[144:147], v[64:67], v[32:35], v[144:147]
    v_mfma_f32_16x16x32_bf16 v[112:115], v[96:99], v[32:35], v[112:115]
    ds_read_b128 v[44:47], v4 offset:61440
    ds_read_b64_tr_b16 v[76:77], v5 offset:15360
    ds_read_b64_tr_b16 v[78:79], v5 offset:15488
    ds_read_b128 v[108:111], v8 offset:960
    s_waitcnt lgkmcnt(8)
    v_mfma_f32_16x16x32_bf16 v[144:147], v[68:71], v[36:39], v[144:147]
    v_mfma_f32_16x16x32_bf16 v[112:115], v[100:103], v[36:39], v[112:115]
    s_waitcnt lgkmcnt(4)
    v_mfma_f32_16x16x32_bf16 v[144:147], v[72:75], v[40:43], v[144:147]
    v_mfma_f32_16x16x32_bf16 v[112:115], v[104:107], v[40:43], v[112:115]
    s_waitcnt lgkmcnt(0)
    v_mfma_f32_16x16x32_bf16 v[144:147], v[76:79], v[44:47], v[144:147]
    v_mfma_f32_16x16x32_bf16 v[112:115], v[108:111], v[44:47], v[112:115]
    s_and_b32 s54, s22, 1
    v_lshl_add_u32 v13, v14, 9, v13
    v_lshl_add_u32 v13, v15, 3, v13
    s_lshl_b32 s54, s54, 8
    s_lshl_b32 s53, s49, 2
    s_add_u32 s53, s53, s22
    s_lshl_b32 s53, s53, 7
    s_add_u32 s53, s53, 81920
    s_mov_b32 s55, 0x3fb8aa3b
    v_mul_f32 v112, s55, v112
    v_exp_f32 v112, -v112
    s_nop 0
    v_add_f32 v112, 1.0, v112
    v_rcp_f32 v112, v112
    s_mov_b32 exec_hi, 0
    buffer_store_dword v112, v156, s[44:47], s53 offen sc1
    s_mov_b32 exec_hi, -1
    s_branch L_jobdone
L_jobV:
    s_waitcnt vmcnt(25)
    s_barrier
    s_waitcnt vmcnt(16)
    ds_read_b128 v[16:19], v4 offset:0
    ds_read_b64_tr_b16 v[48:49], v5 offset:0
    ds_read_b64_tr_b16 v[50:51], v5 offset:128
    ds_read_b128 v[20:23], v4 offset:4096
    ds_read_b64_tr_b16 v[52:53], v5 offset:1024
    ds_read_b64_tr_b16 v[54:55], v5 offset:1152
    ds_read_b128 v[24:27], v4 offset:8192
    ds_read_b64_tr_b16 v[56:57], v5 offset:2048
    ds_read_b64_tr_b16 v[58:59], v5 offset:2176
    s_waitcnt lgkmcnt(6)
    v_mfma_f32_16x16x32_bf16 v[144:147], v[16:19], v[48:51], 0
    ds_read_b128 v[28:31], v4 offset:12288
    ds_read_b64_tr_b16 v[60:61], v5 offset:3072
    ds_read_b64_tr_b16 v[62:63], v5 offset:3200
    s_waitcnt lgkmcnt(6)
    v_mfma_f32_16x16x32_bf16 v[144:147], v[20:23], v[52:55], v[144:147]
    ds_read_b128 v[32:35], v4 offset:16384
    ds_read_b64_tr_b16 v[64:65], v5 offset:4096
    ds_read_b64_tr_b16 v[66:67], v5 offset:4224
    s_waitcnt lgkmcnt(6)
    v_mfma_f32_16x16x32_bf16 v[144:147], v[24:27], v[56:59], v[144:147]
    ds_read_b128 v[36:39], v4 offset:20480
    ds_read_b64_tr_b16 v[68:69], v5 offset:5120
    ds_read_b64_tr_b16 v[70:71], v5 offset:5248
    s_waitcnt lgkmcnt(6)
    v_mfma_f32_16x16x32_bf16 v[144:147], v[28:31], v[60:63], v[144:147]
    ds_read_b128 v[40:43], v4 offset:24576
    ds_read_b64_tr_b16 v[72:73], v5 offset:6144
    ds_read_b64_tr_b16 v[74:75], v5 offset:6272
    s_waitcnt lgkmcnt(6)
    v_mfma_f32_16x16x32_bf16 v[144:147], v[32:35], v[64:67], v[144:147]
    ds_read_b128 v[44:47], v4 offset:28672
    ds_read_b64_tr_b16 v[76:77], v5 offset:7168
    ds_read_b64_tr_b16 v[78:79], v5 offset:7296
    s_waitcnt lgkmcnt(6)
    v_mfma_f32_16x16x32_bf16 v[144:147], v[36:39], v[68:71], v[144:147]
    s_waitcnt lgkmcnt(3)
    v_mfma_f32_16x16x32_bf16 v[144:147], v[40:43], v[72:75], v[144:147]
    s_waitcnt lgkmcnt(0)
    v_mfma_f32_16x16x32_bf16 v[144:147], v[44:47], v[76:79], v[144:147]
    s_waitcnt vmcnt(8)
    s_barrier
    s_waitcnt vmcnt(0)
    ds_read_b128 v[16:19], v4 offset:32768
    ds_read_b64_tr_b16 v[48:49], v5 offset:8192
    ds_read_b64_tr_b16 v[50:51], v5 offset:8320
    ds_read_b128 v[20:23], v4 offset:36864
    ds_read_b64_tr_b16 v[52:53], v5 offset:9216
    ds_read_b64_tr_b16 v[54:55], v5 offset:9344
    ds_read_b128 v[24:27], v4 offset:40960
    ds_read_b64_tr_b16 v[56:57], v5 offset:10240
    ds_read_b64_tr_b16 v[58:59], v5 offset:10368
    s_waitcnt lgkmcnt(6)
    v_mfma_f32_16x16x32_bf16 v[144:147], v[16:19], v[48:51], v[144:147]
    ds_read_b128 v[28:31], v4 offset:45056
    ds_read_b64_tr_b16 v[60:61], v5 offset:11264
    ds_read_b64_tr_b16 v[62:63], v5 offset:11392
    s_waitcnt lgkmcnt(6)
    v_mfma_f32_16x16x32_bf16 v[144:147], v[20:23], v[52:55], v[144:147]
    ds_read_b128 v[32:35], v4 offset:49152
    ds_read_b64_tr_b16 v[64:65], v5 offset:12288
    ds_read_b64_tr_b16 v[66:67], v5 offset:12416
    s_waitcnt lgkmcnt(6)
    v_mfma_f32_16x16x32_bf16 v[144:147], v[24:27], v[56:59], v[144:147]
    ds_read_b128 v[36:39], v4 offset:53248
    ds_read_b64_tr_b16 v[68:69], v5 offset:13312
    ds_read_b64_tr_b16 v[70:71], v5 offset:13440
    s_waitcnt lgkmcnt(6)
    v_mfma_f32_16x16x32_bf16 v[144:147], v[28:31], v[60:63], v[144:147]
    ds_read_b128 v[40:43], v4 offset:57344
    ds_read_b64_tr_b16 v[72:73], v5 offset:14336
    ds_read_b64_tr_b16 v[74:75], v5 offset:14464
    s_waitcnt lgkmcnt(6)
    v_mfma_f32_16x16x32_bf16 v[144:147], v[32:35], v[64:67], v[144:147]
    ds_read_b128 v[44:47], v4 offset:61440
    ds_read_b64_tr_b16 v[76:77], v5 offset:15360
    ds_read_b64_tr_b16 v[78:79], v5 offset:15488
    s_waitcnt lgkmcnt(6)
    v_mfma_f32_16x16x32_bf16 v[144:147], v[36:39], v[68:71], v[144:147]
    s_waitcnt lgkmcnt(3)
    v_mfma_f32_16x16x32_bf16 v[144:147], v[40:43], v[72:75], v[144:147]
    s_waitcnt lgkmcnt(0)
    v_mfma_f32_16x16x32_bf16 v[144:147], v[44:47], v[76:79], v[144:147]
    s_and_b32 s54, s22, 1
    v_lshl_add_u32 v13, v15, 8, v13
    v_lshl_add_u32 v13, v14, 3, v13
    s_lshl_b32 s54, s54, 9
    s_add_u32 s54, s54, 1024
L_jobdone:
    s_lshl_b32 s53, s61, 11
    s_add_u32 s53, s53, s54
    s_add_u32 s53, s53, 131072
    s_nop 1
    v_cvt_pk_bf16_f32 v148, v144, v145
    v_cvt_pk_bf16_f32 v149, v146, v147
    v_mov_b32 v16, v148
    v_mov_b32 v17, v158
    v_mov_b32 v18, v149
    v_mov_b32 v19, v158
    s_lshl_b32 s54, s61, 2
    s_and_b32 s55, s50, 3
    s_add_u32 s54, s54, s55
    s_lshl_b32 s54, s54, 10
    s_add_u32 s54, s54, 524288
    buffer_store_dwordx4 v[16:19], v11, s[44:47], s54 offen sc1
    v_mov_b32 v14, 0
    s_lshl_b32 s54, s2, 8
    s_add_u32 s54, s54, 262144
    buffer_store_dwordx2 v[148:149], v13, s[44:47], s53 offen sc1
    buffer_store_dword v14, v156, s[44:47], s54 offen sc1
    s_barrier
    s_mov_b32 s32, s78
    s_mov_b32 s33, s79
    s_mov_b32 s34, 0x180000
    s_mov_b32 s35, 0x20000
    s_mov_b32 s44, s98
    s_mov_b32 s45, s99
    s_mov_b32 s46, 0x1000000
    s_mov_b32 s47, 0x20000
    s_mov_b32 s64, 0xffff
    s_mov_b32 s65, 0xffff
    s_mov_b32 s70, 0x3fb8aa3b
    s_mov_b32 s71, 0x3fb8aa3b
    s_mov_b32 s20, 0x358637bd
    s_mov_b32 s21, 0x3f803f80
    v_lshrrev_b32 v2, 3, v1
    v_bfe_u32 v3, v1, 4, 1
    v_lshlrev_b32 v3, 2, v3
    v_xor_b32 v3, v3, v1
    v_and_b32 v3, 7, v3
    v_lshlrev_b32 v3, 4, v3
    v_mul_u32_u24 v2, 3072, v2
    v_add_u32 v153, v2, v3
    v_add_u32 v154, 23552, v153
    s_sub_u32 s27, s48, 8
    s_and_b32 s51, s27, 1
    s_lshl_b32 s60, s27, 13
    s_add_u32 s60, s60, 131072
    s_lshl_b32 s59, s23, 7
    s_cmp_lt_u32 s27, 2
    s_cselect_b32 s54, 2, 1
    s_cselect_b32 s55, 0, s20
    s_lshl_b32 s54, s54, 10
    s_add_u32 s59, s59, s54
    s_barrier
    v_and_b32 v2, 15, v1
    v_lshlrev_b32 v2, 4, v2
    v_bfe_u32 v3, v1, 4, 1
    v_lshrrev_b32 v4, 5, v1
    v_lshl_add_u32 v12, v3, 9, v2
    v_lshl_add_u32 v12, v4, 3, v12
    v_lshl_add_u32 v155, v4, 8, v2
    v_lshl_add_u32 v155, v3, 3, v155
    s_lshl_b32 s7, s63, 12
    s_add_u32 s7, s7, 524288
    s_barrier
    s_waitcnt vmcnt(0)
    s_mov_b64 exec, 1
    buffer_store_dword v158, v156, s[44:47], s56 offen sc1
    s_mov_b64 exec, -1
    s_barrier
    v_and_b32 v2, 31, v1
    v_lshrrev_b32 v3, 5, v1
    v_bfe_u32 v4, v1, 2, 2
    v_xor_b32 v4, v4, v3
    v_lshlrev_b32 v4, 4, v4
    v_lshl_add_u32 v5, v2, 6, v4
    s_lshl_b32 s53, s51, 11
    s_add_u32 s53, s53, 65536
    v_add_u32 v8, s53, v5
    v_xor_b32 v9, 32, v8
    v_lshlrev_b32 v2, 10, v3
    v_bfe_u32 v3, v1, 2, 2
    v_lshl_add_u32 v2, v3, 7, v2
    v_bfe_u32 v3, v1, 3, 1
    v_lshl_add_u32 v2, v3, 6, v2
    v_bfe_u32 v3, v1, 4, 1
    v_lshl_add_u32 v2, v3, 5, v2
    v_and_b32 v3, 3, v1
    v_lshl_add_u32 v2, v3, 3, v2
    v_add_u32 v159, s60, v2
    v_xor_b32 v160, 64, v159
    s_barrier
    s_add_u32 s53, s7, 0
    buffer_load_dwordx4 v[80:83], v11, s[44:47], s53 offen offset:0 sc1
    buffer_load_dwordx4 v[84:87], v11, s[44:47], s53 offen offset:1024 sc1
    buffer_load_dwordx4 v[88:91], v11, s[44:47], s53 offen offset:2048 sc1
    buffer_load_dwordx4 v[92:95], v11, s[44:47], s53 offen offset:3072 sc1
    s_add_u32 s53, s7, 4096
    buffer_load_dwordx4 v[96:99], v11, s[44:47], s53 offen offset:0 sc1
    buffer_load_dwordx4 v[100:103], v11, s[44:47], s53 offen offset:1024 sc1
    buffer_load_dwordx4 v[104:107], v11, s[44:47], s53 offen offset:2048 sc1
    buffer_load_dwordx4 v[108:111], v11, s[44:47], s53 offen offset:3072 sc1
    s_add_u32 s53, s7, 8192
    buffer_load_dwordx4 v[112:115], v11, s[44:47], s53 offen offset:0 sc1
    buffer_load_dwordx4 v[116:119], v11, s[44:47], s53 offen offset:1024 sc1
    buffer_load_dwordx4 v[120:123], v11, s[44:47], s53 offen offset:2048 sc1
    buffer_load_dwordx4 v[124:127], v11, s[44:47], s53 offen offset:3072 sc1
    s_add_u32 s53, s7, 12288
    buffer_load_dwordx4 v[128:131], v11, s[44:47], s53 offen offset:0 sc1
    buffer_load_dwordx4 v[132:135], v11, s[44:47], s53 offen offset:1024 sc1
    buffer_load_dwordx4 v[136:139], v11, s[44:47], s53 offen offset:2048 sc1
    buffer_load_dwordx4 v[140:143], v11, s[44:47], s53 offen offset:3072 sc1
    s_barrier
    s_mov_b32 s62, 0
L_tg0_loop:
    s_waitcnt vmcnt(0)
    v_min3_u32 v2, v158, v81, v83
    v_max3_u32 v3, v158, v81, v83
    v_min3_u32 v2, v2, v85, v87
    v_max3_u32 v3, v3, v85, v87
    v_min3_u32 v2, v2, v89, v91
    v_max3_u32 v3, v3, v89, v91
    v_min3_u32 v2, v2, v93, v95
    v_max3_u32 v3, v3, v93, v95
    v_min3_u32 v2, v2, v97, v99
    v_max3_u32 v3, v3, v97, v99
    v_min3_u32 v2, v2, v101, v103
    v_max3_u32 v3, v3, v101, v103
    v_min3_u32 v2, v2, v105, v107
    v_max3_u32 v3, v3, v105, v107
    v_min3_u32 v2, v2, v109, v111
    v_max3_u32 v3, v3, v109, v111
    v_min3_u32 v2, v2, v113, v115
    v_max3_u32 v3, v3, v113, v115
    v_min3_u32 v2, v2, v117, v119
    v_max3_u32 v3, v3, v117, v119
    v_min3_u32 v2, v2, v121, v123
    v_max3_u32 v3, v3, v121, v123
    v_min3_u32 v2, v2, v125, v127
    v_max3_u32 v3, v3, v125, v127
    v_min3_u32 v2, v2, v129, v131
    v_max3_u32 v3, v3, v129, v131
    v_min3_u32 v2, v2, v133, v135
    v_max3_u32 v3, v3, v133, v135
    v_min3_u32 v2, v2, v137, v139
    v_max3_u32 v3, v3, v137, v139
    v_min3_u32 v2, v2, v141, v143
    v_max3_u32 v3, v3, v141, v143
    v_cmp_ne_u32 vcc, v2, v3
    s_cbranch_vccz L_tg0_ok
    s_add_u32 s62, s62, 1
    s_cmp_ge_u32 s62, 100000
    s_cbranch_scc1 L_tg0_ok
    s_add_u32 s53, s7, 0
    buffer_load_dwordx4 v[80:83], v11, s[44:47], s53 offen offset:0 sc1
    buffer_load_dwordx4 v[84:87], v11, s[44:47], s53 offen offset:1024 sc1
    buffer_load_dwordx4 v[88:91], v11, s[44:47], s53 offen offset:2048 sc1
    buffer_load_dwordx4 v[92:95], v11, s[44:47], s53 offen offset:3072 sc1
    s_add_u32 s53, s7, 4096
    buffer_load_dwordx4 v[96:99], v11, s[44:47], s53 offen offset:0 sc1
    buffer_load_dwordx4 v[100:103], v11, s[44:47], s53 offen offset:1024 sc1
    buffer_load_dwordx4 v[104:107], v11, s[44:47], s53 offen offset:2048 sc1
    buffer_load_dwordx4 v[108:111], v11, s[44:47], s53 offen offset:3072 sc1
    s_add_u32 s53, s7, 8192
    buffer_load_dwordx4 v[112:115], v11, s[44:47], s53 offen offset:0 sc1
    buffer_load_dwordx4 v[116:119], v11, s[44:47], s53 offen offset:1024 sc1
    buffer_load_dwordx4 v[120:123], v11, s[44:47], s53 offen offset:2048 sc1
    buffer_load_dwordx4 v[124:127], v11, s[44:47], s53 offen offset:3072 sc1
    s_add_u32 s53, s7, 12288
    buffer_load_dwordx4 v[128:131], v11, s[44:47], s53 offen offset:0 sc1
    buffer_load_dwordx4 v[132:135], v11, s[44:47], s53 offen offset:1024 sc1
    buffer_load_dwordx4 v[136:139], v11, s[44:47], s53 offen offset:2048 sc1
    buffer_load_dwordx4 v[140:143], v11, s[44:47], s53 offen offset:3072 sc1
    s_branch L_tg0_loop
L_tg0_ok:
    v_mov_b32 v81, v82
    v_mov_b32 v85, v86
    v_mov_b32 v89, v90
    v_mov_b32 v93, v94
    ds_write_b64 v12, v[80:81] offset:0
    ds_write_b64 v155, v[84:85] offset:1024
    ds_write_b64 v12, v[88:89] offset:256
    ds_write_b64 v155, v[92:93] offset:1536
    v_mov_b32 v97, v98
    v_mov_b32 v101, v102
    v_mov_b32 v105, v106
    v_mov_b32 v109, v110
    ds_write_b64 v12, v[96:97] offset:2048
    ds_write_b64 v155, v[100:101] offset:3072
    ds_write_b64 v12, v[104:105] offset:2304
    ds_write_b64 v155, v[108:109] offset:3584
    v_mov_b32 v113, v114
    v_mov_b32 v117, v118
    v_mov_b32 v121, v122
    v_mov_b32 v125, v126
    ds_write_b64 v12, v[112:113] offset:4096
    ds_write_b64 v155, v[116:117] offset:5120
    ds_write_b64 v12, v[120:121] offset:4352
    ds_write_b64 v155, v[124:125] offset:5632
    v_mov_b32 v129, v130
    v_mov_b32 v133, v134
    v_mov_b32 v137, v138
    v_mov_b32 v141, v142
    s_waitcnt lgkmcnt(8)
    ds_write_b64 v12, v[128:129] offset:6144
    ds_write_b64 v155, v[132:133] offset:7168
    ds_write_b64 v12, v[136:137] offset:6400
    ds_write_b64 v155, v[140:141] offset:7680
    s_waitcnt lgkmcnt(0)
    s_barrier
L_kv01:
    s_add_u32 m0, s60, 0
    s_xor_b32 s58, s69, 0
    s_mul_i32 s58, s58, 196608
    s_add_u32 s58, s58, s59
    buffer_load_dwordx4 v153, s[32:35], s58 offen lds
    buffer_load_dwordx4 v154, s[32:35], s58 offen offset:1024 lds
    s_add_u32 m0, s60, 2048
    s_add_u32 s58, s58, 49152
    buffer_load_dwordx4 v153, s[32:35], s58 offen lds
    buffer_load_dwordx4 v154, s[32:35], s58 offen offset:1024 lds
    s_add_u32 m0, s60, 4096
    s_add_u32 s58, s58, 49152
    buffer_load_dwordx4 v153, s[32:35], s58 offen lds
    buffer_load_dwordx4 v154, s[32:35], s58 offen offset:1024 lds
    s_add_u32 m0, s60, 6144
    s_add_u32 s58, s58, 49152
    buffer_load_dwordx4 v153, s[32:35], s58 offen lds
    buffer_load_dwordx4 v154, s[32:35], s58 offen offset:1024 lds
    s_waitcnt vmcnt(6)
    ds_read_b128 v[56:59], v8 offset:0
    ds_read_b64_tr_b16 v[60:61], v159 offset:0
    ds_read_b64_tr_b16 v[62:63], v159 offset:512
    ds_read_b64_tr_b16 v[64:65], v160 offset:0
    ds_read_b64_tr_b16 v[66:67], v160 offset:512
    s_waitcnt vmcnt(4)
    ds_read_b128 v[68:71], v9 offset:0
    ds_read_b64_tr_b16 v[72:73], v159 offset:2048
    ds_read_b64_tr_b16 v[74:75], v159 offset:2560
    ds_read_b64_tr_b16 v[76:77], v160 offset:2048
    ds_read_b64_tr_b16 v[78:79], v160 offset:2560
    s_waitcnt lgkmcnt(5)
    v_mfma_f32_32x32x16_bf16 v[24:39], v[56:59], v[60:63], 0
    v_mfma_f32_32x32x16_bf16 v[40:55], v[56:59], v[64:67], 0
    s_add_u32 m0, s60, 0
    s_xor_b32 s58, s69, 1
    s_mul_i32 s58, s58, 196608
    s_add_u32 s58, s58, s59
    buffer_load_dwordx4 v153, s[32:35], s58 offen lds
    buffer_load_dwordx4 v154, s[32:35], s58 offen offset:1024 lds
    s_waitcnt vmcnt(4)
    ds_read_b128 v[56:59], v8 offset:4096
    ds_read_b64_tr_b16 v[60:61], v159 offset:4096
    ds_read_b64_tr_b16 v[62:63], v159 offset:4608
    ds_read_b64_tr_b16 v[64:65], v160 offset:4096
    ds_read_b64_tr_b16 v[66:67], v160 offset:4608
    s_waitcnt lgkmcnt(5)
    v_mfma_f32_32x32x16_bf16 v[24:39], v[68:71], v[72:75], v[24:39]
    v_mfma_f32_32x32x16_bf16 v[40:55], v[68:71], v[76:79], v[40:55]
    s_add_u32 m0, s60, 2048
    s_add_u32 s58, s58, 49152
    buffer_load_dwordx4 v153, s[32:35], s58 offen lds
    buffer_load_dwordx4 v154, s[32:35], s58 offen offset:1024 lds
    s_waitcnt vmcnt(4)
    ds_read_b128 v[68:71], v9 offset:4096
    ds_read_b64_tr_b16 v[72:73], v159 offset:6144
    ds_read_b64_tr_b16 v[74:75], v159 offset:6656
    ds_read_b64_tr_b16 v[76:77], v160 offset:6144
    ds_read_b64_tr_b16 v[78:79], v160 offset:6656
    s_waitcnt lgkmcnt(5)
    v_mfma_f32_32x32x16_bf16 v[24:39], v[56:59], v[60:63], v[24:39]
    v_mfma_f32_32x32x16_bf16 v[40:55], v[56:59], v[64:67], v[40:55]
    s_add_u32 m0, s60, 4096
    s_add_u32 s58, s58, 49152
    buffer_load_dwordx4 v153, s[32:35], s58 offen lds
    buffer_load_dwordx4 v154, s[32:35], s58 offen offset:1024 lds
    s_waitcnt vmcnt(4)
    ds_read_b128 v[56:59], v8 offset:8192
    ds_read_b64_tr_b16 v[60:61], v159 offset:0
    ds_read_b64_tr_b16 v[62:63], v159 offset:512
    ds_read_b64_tr_b16 v[64:65], v160 offset:0
    ds_read_b64_tr_b16 v[66:67], v160 offset:512
    s_waitcnt lgkmcnt(5)
    v_mfma_f32_32x32x16_bf16 v[24:39], v[68:71], v[72:75], v[24:39]
    v_mfma_f32_32x32x16_bf16 v[40:55], v[68:71], v[76:79], v[40:55]
    s_add_u32 m0, s60, 6144
    s_add_u32 s58, s58, 49152
    buffer_load_dwordx4 v153, s[32:35], s58 offen lds
    buffer_load_dwordx4 v154, s[32:35], s58 offen offset:1024 lds
    s_waitcnt vmcnt(4)
    ds_read_b128 v[68:71], v9 offset:8192
    ds_read_b64_tr_b16 v[72:73], v159 offset:2048
    ds_read_b64_tr_b16 v[74:75], v159 offset:2560
    ds_read_b64_tr_b16 v[76:77], v160 offset:2048
    ds_read_b64_tr_b16 v[78:79], v160 offset:2560
    s_waitcnt lgkmcnt(5)
    v_mfma_f32_32x32x16_bf16 v[24:39], v[56:59], v[60:63], v[24:39]
    v_mfma_f32_32x32x16_bf16 v[40:55], v[56:59], v[64:67], v[40:55]
    s_add_u32 m0, s60, 0
    s_xor_b32 s58, s69, 2
    s_mul_i32 s58, s58, 196608
    s_add_u32 s58, s58, s59
    buffer_load_dwordx4 v153, s[32:35], s58 offen lds
    buffer_load_dwordx4 v154, s[32:35], s58 offen offset:1024 lds
    s_waitcnt vmcnt(4)
    ds_read_b128 v[56:59], v8 offset:12288
    ds_read_b64_tr_b16 v[60:61], v159 offset:4096
    ds_read_b64_tr_b16 v[62:63], v159 offset:4608
    ds_read_b64_tr_b16 v[64:65], v160 offset:4096
    ds_read_b64_tr_b16 v[66:67], v160 offset:4608
    s_waitcnt lgkmcnt(5)
    v_mfma_f32_32x32x16_bf16 v[24:39], v[68:71], v[72:75], v[24:39]
    v_mfma_f32_32x32x16_bf16 v[40:55], v[68:71], v[76:79], v[40:55]
    s_add_u32 m0, s60, 2048
    s_add_u32 s58, s58, 49152
    buffer_load_dwordx4 v153, s[32:35], s58 offen lds
    buffer_load_dwordx4 v154, s[32:35], s58 offen offset:1024 lds
    s_waitcnt vmcnt(4)
    ds_read_b128 v[68:71], v9 offset:12288
    ds_read_b64_tr_b16 v[72:73], v159 offset:6144
    ds_read_b64_tr_b16 v[74:75], v159 offset:6656
    ds_read_b64_tr_b16 v[76:77], v160 offset:6144
    ds_read_b64_tr_b16 v[78:79], v160 offset:6656
    s_waitcnt lgkmcnt(5)
    v_mfma_f32_32x32x16_bf16 v[24:39], v[56:59], v[60:63], v[24:39]
    v_mfma_f32_32x32x16_bf16 v[40:55], v[56:59], v[64:67], v[40:55]
    s_add_u32 m0, s60, 4096
    s_add_u32 s58, s58, 49152
    buffer_load_dwordx4 v153, s[32:35], s58 offen lds
    buffer_load_dwordx4 v154, s[32:35], s58 offen offset:1024 lds
    s_waitcnt vmcnt(4)
    s_barrier
    ds_read_b128 v[56:59], v8 offset:16384
    ds_read_b64_tr_b16 v[60:61], v159 offset:0
    ds_read_b64_tr_b16 v[62:63], v159 offset:512
    ds_read_b64_tr_b16 v[64:65], v160 offset:0
    ds_read_b64_tr_b16 v[66:67], v160 offset:512
    s_waitcnt lgkmcnt(5)
    v_mfma_f32_32x32x16_bf16 v[24:39], v[68:71], v[72:75], v[24:39]
    v_mfma_f32_32x32x16_bf16 v[40:55], v[68:71], v[76:79], v[40:55]
    s_add_u32 m0, s60, 6144
    s_add_u32 s58, s58, 49152
    buffer_load_dwordx4 v153, s[32:35], s58 offen lds
    buffer_load_dwordx4 v154, s[32:35], s58 offen offset:1024 lds
    s_waitcnt vmcnt(4)
    ds_read_b128 v[68:71], v9 offset:16384
    ds_read_b64_tr_b16 v[72:73], v159 offset:2048
    ds_read_b64_tr_b16 v[74:75], v159 offset:2560
    ds_read_b64_tr_b16 v[76:77], v160 offset:2048
    ds_read_b64_tr_b16 v[78:79], v160 offset:2560
    s_waitcnt lgkmcnt(5)
    v_mfma_f32_32x32x16_bf16 v[24:39], v[56:59], v[60:63], v[24:39]
    v_mfma_f32_32x32x16_bf16 v[40:55], v[56:59], v[64:67], v[40:55]
    s_add_u32 m0, s60, 0
    s_xor_b32 s58, s69, 3
    s_mul_i32 s58, s58, 196608
    s_add_u32 s58, s58, s59
    buffer_load_dwordx4 v153, s[32:35], s58 offen lds
    buffer_load_dwordx4 v154, s[32:35], s58 offen offset:1024 lds
    s_waitcnt vmcnt(4)
    ds_read_b128 v[56:59], v8 offset:20480
    ds_read_b64_tr_b16 v[60:61], v159 offset:4096
    ds_read_b64_tr_b16 v[62:63], v159 offset:4608
    ds_read_b64_tr_b16 v[64:65], v160 offset:4096
    ds_read_b64_tr_b16 v[66:67], v160 offset:4608
    s_waitcnt lgkmcnt(5)
    v_mfma_f32_32x32x16_bf16 v[24:39], v[68:71], v[72:75], v[24:39]
    v_mfma_f32_32x32x16_bf16 v[40:55], v[68:71], v[76:79], v[40:55]
    s_add_u32 m0, s60, 2048
    s_add_u32 s58, s58, 49152
    buffer_load_dwordx4 v153, s[32:35], s58 offen lds
    buffer_load_dwordx4 v154, s[32:35], s58 offen offset:1024 lds
    s_waitcnt vmcnt(4)
    ds_read_b128 v[68:71], v9 offset:20480
    ds_read_b64_tr_b16 v[72:73], v159 offset:6144
    ds_read_b64_tr_b16 v[74:75], v159 offset:6656
    ds_read_b64_tr_b16 v[76:77], v160 offset:6144
    ds_read_b64_tr_b16 v[78:79], v160 offset:6656
    s_waitcnt lgkmcnt(5)
    v_mfma_f32_32x32x16_bf16 v[24:39], v[56:59], v[60:63], v[24:39]
    v_mfma_f32_32x32x16_bf16 v[40:55], v[56:59], v[64:67], v[40:55]
    s_add_u32 m0, s60, 4096
    s_add_u32 s58, s58, 49152
    buffer_load_dwordx4 v153, s[32:35], s58 offen lds
    buffer_load_dwordx4 v154, s[32:35], s58 offen offset:1024 lds
    s_waitcnt vmcnt(4)
    ds_read_b128 v[56:59], v8 offset:24576
    ds_read_b64_tr_b16 v[60:61], v159 offset:0
    ds_read_b64_tr_b16 v[62:63], v159 offset:512
    ds_read_b64_tr_b16 v[64:65], v160 offset:0
    ds_read_b64_tr_b16 v[66:67], v160 offset:512
    s_waitcnt lgkmcnt(5)
    v_mfma_f32_32x32x16_bf16 v[24:39], v[68:71], v[72:75], v[24:39]
    v_mfma_f32_32x32x16_bf16 v[40:55], v[68:71], v[76:79], v[40:55]
    s_add_u32 m0, s60, 6144
    s_add_u32 s58, s58, 49152
    buffer_load_dwordx4 v153, s[32:35], s58 offen lds
    buffer_load_dwordx4 v154, s[32:35], s58 offen offset:1024 lds
    s_waitcnt vmcnt(4)
    ds_read_b128 v[68:71], v9 offset:24576
    ds_read_b64_tr_b16 v[72:73], v159 offset:2048
    ds_read_b64_tr_b16 v[74:75], v159 offset:2560
    ds_read_b64_tr_b16 v[76:77], v160 offset:2048
    ds_read_b64_tr_b16 v[78:79], v160 offset:2560
    s_waitcnt lgkmcnt(5)
    v_mfma_f32_32x32x16_bf16 v[24:39], v[56:59], v[60:63], v[24:39]
    v_mfma_f32_32x32x16_bf16 v[40:55], v[56:59], v[64:67], v[40:55]
    s_add_u32 m0, s60, 0
    s_xor_b32 s58, s69, 4
    s_mul_i32 s58, s58, 196608
    s_add_u32 s58, s58, s59
    buffer_load_dwordx4 v153, s[32:35], s58 offen lds
    buffer_load_dwordx4 v154, s[32:35], s58 offen offset:1024 lds
    s_waitcnt vmcnt(4)
    ds_read_b128 v[56:59], v8 offset:28672
    ds_read_b64_tr_b16 v[60:61], v159 offset:4096
    ds_read_b64_tr_b16 v[62:63], v159 offset:4608
    ds_read_b64_tr_b16 v[64:65], v160 offset:4096
    ds_read_b64_tr_b16 v[66:67], v160 offset:4608
    s_waitcnt lgkmcnt(5)
    v_mfma_f32_32x32x16_bf16 v[24:39], v[68:71], v[72:75], v[24:39]
    v_mfma_f32_32x32x16_bf16 v[40:55], v[68:71], v[76:79], v[40:55]
    s_add_u32 m0, s60, 2048
    s_add_u32 s58, s58, 49152
    buffer_load_dwordx4 v153, s[32:35], s58 offen lds
    buffer_load_dwordx4 v154, s[32:35], s58 offen offset:1024 lds
    s_waitcnt vmcnt(4)
    ds_read_b128 v[68:71], v9 offset:28672
    ds_read_b64_tr_b16 v[72:73], v159 offset:6144
    ds_read_b64_tr_b16 v[74:75], v159 offset:6656
    ds_read_b64_tr_b16 v[76:77], v160 offset:6144
    ds_read_b64_tr_b16 v[78:79], v160 offset:6656
    s_waitcnt lgkmcnt(5)
    v_mfma_f32_32x32x16_bf16 v[24:39], v[56:59], v[60:63], v[24:39]
    v_mfma_f32_32x32x16_bf16 v[40:55], v[56:59], v[64:67], v[40:55]
    s_add_u32 m0, s60, 4096
    s_add_u32 s58, s58, 49152
    buffer_load_dwordx4 v153, s[32:35], s58 offen lds
    buffer_load_dwordx4 v154, s[32:35], s58 offen offset:1024 lds
    s_waitcnt vmcnt(4)
    ds_read_b128 v[56:59], v8 offset:32768
    ds_read_b64_tr_b16 v[60:61], v159 offset:0
    ds_read_b64_tr_b16 v[62:63], v159 offset:512
    ds_read_b64_tr_b16 v[64:65], v160 offset:0
    ds_read_b64_tr_b16 v[66:67], v160 offset:512
    s_waitcnt lgkmcnt(5)
    v_mfma_f32_32x32x16_bf16 v[24:39], v[68:71], v[72:75], v[24:39]
    v_mfma_f32_32x32x16_bf16 v[40:55], v[68:71], v[76:79], v[40:55]
    s_add_u32 m0, s60, 6144
    s_add_u32 s58, s58, 49152
    buffer_load_dwordx4 v153, s[32:35], s58 offen lds
    buffer_load_dwordx4 v154, s[32:35], s58 offen offset:1024 lds
    s_waitcnt vmcnt(4)
    ds_read_b128 v[68:71], v9 offset:32768
    ds_read_b64_tr_b16 v[72:73], v159 offset:2048
    ds_read_b64_tr_b16 v[74:75], v159 offset:2560
    ds_read_b64_tr_b16 v[76:77], v160 offset:2048
    ds_read_b64_tr_b16 v[78:79], v160 offset:2560
    s_waitcnt lgkmcnt(5)
    v_mfma_f32_32x32x16_bf16 v[24:39], v[56:59], v[60:63], v[24:39]
    v_mfma_f32_32x32x16_bf16 v[40:55], v[56:59], v[64:67], v[40:55]
    s_add_u32 m0, s60, 0
    s_xor_b32 s58, s69, 5
    s_mul_i32 s58, s58, 196608
    s_add_u32 s58, s58, s59
    buffer_load_dwordx4 v153, s[32:35], s58 offen lds
    buffer_load_dwordx4 v154, s[32:35], s58 offen offset:1024 lds
    s_waitcnt vmcnt(4)
    ds_read_b128 v[56:59], v8 offset:36864
    ds_read_b64_tr_b16 v[60:61], v159 offset:4096
    ds_read_b64_tr_b16 v[62:63], v159 offset:4608
    ds_read_b64_tr_b16 v[64:65], v160 offset:4096
    ds_read_b64_tr_b16 v[66:67], v160 offset:4608
    s_waitcnt lgkmcnt(5)
    v_mfma_f32_32x32x16_bf16 v[24:39], v[68:71], v[72:75], v[24:39]
    v_mfma_f32_32x32x16_bf16 v[40:55], v[68:71], v[76:79], v[40:55]
    s_add_u32 m0, s60, 2048
    s_add_u32 s58, s58, 49152
    buffer_load_dwordx4 v153, s[32:35], s58 offen lds
    buffer_load_dwordx4 v154, s[32:35], s58 offen offset:1024 lds
    s_waitcnt vmcnt(4)
    ds_read_b128 v[68:71], v9 offset:36864
    ds_read_b64_tr_b16 v[72:73], v159 offset:6144
    ds_read_b64_tr_b16 v[74:75], v159 offset:6656
    ds_read_b64_tr_b16 v[76:77], v160 offset:6144
    ds_read_b64_tr_b16 v[78:79], v160 offset:6656
    s_waitcnt lgkmcnt(5)
    v_mfma_f32_32x32x16_bf16 v[24:39], v[56:59], v[60:63], v[24:39]
    v_mfma_f32_32x32x16_bf16 v[40:55], v[56:59], v[64:67], v[40:55]
    s_add_u32 m0, s60, 4096
    s_add_u32 s58, s58, 49152
    buffer_load_dwordx4 v153, s[32:35], s58 offen lds
    buffer_load_dwordx4 v154, s[32:35], s58 offen offset:1024 lds
    s_waitcnt vmcnt(4)
    ds_read_b128 v[56:59], v8 offset:40960
    ds_read_b64_tr_b16 v[60:61], v159 offset:0
    ds_read_b64_tr_b16 v[62:63], v159 offset:512
    ds_read_b64_tr_b16 v[64:65], v160 offset:0
    ds_read_b64_tr_b16 v[66:67], v160 offset:512
    s_waitcnt lgkmcnt(5)
    v_mfma_f32_32x32x16_bf16 v[24:39], v[68:71], v[72:75], v[24:39]
    v_mfma_f32_32x32x16_bf16 v[40:55], v[68:71], v[76:79], v[40:55]
    s_add_u32 m0, s60, 6144
    s_add_u32 s58, s58, 49152
    buffer_load_dwordx4 v153, s[32:35], s58 offen lds
    buffer_load_dwordx4 v154, s[32:35], s58 offen offset:1024 lds
    s_waitcnt vmcnt(4)
    ds_read_b128 v[68:71], v9 offset:40960
    ds_read_b64_tr_b16 v[72:73], v159 offset:2048
    ds_read_b64_tr_b16 v[74:75], v159 offset:2560
    ds_read_b64_tr_b16 v[76:77], v160 offset:2048
    ds_read_b64_tr_b16 v[78:79], v160 offset:2560
    s_waitcnt lgkmcnt(5)
    v_mfma_f32_32x32x16_bf16 v[24:39], v[56:59], v[60:63], v[24:39]
    v_mfma_f32_32x32x16_bf16 v[40:55], v[56:59], v[64:67], v[40:55]
    s_add_u32 m0, s60, 0
    s_xor_b32 s58, s69, 6
    s_mul_i32 s58, s58, 196608
    s_add_u32 s58, s58, s59
    buffer_load_dwordx4 v153, s[32:35], s58 offen lds
    buffer_load_dwordx4 v154, s[32:35], s58 offen offset:1024 lds
    s_waitcnt vmcnt(4)
    ds_read_b128 v[56:59], v8 offset:45056
    ds_read_b64_tr_b16 v[60:61], v159 offset:4096
    ds_read_b64_tr_b16 v[62:63], v159 offset:4608
    ds_read_b64_tr_b16 v[64:65], v160 offset:4096
    ds_read_b64_tr_b16 v[66:67], v160 offset:4608
    s_waitcnt lgkmcnt(5)
    v_mfma_f32_32x32x16_bf16 v[24:39], v[68:71], v[72:75], v[24:39]
    v_mfma_f32_32x32x16_bf16 v[40:55], v[68:71], v[76:79], v[40:55]
    s_add_u32 m0, s60, 2048
    s_add_u32 s58, s58, 49152
    buffer_load_dwordx4 v153, s[32:35], s58 offen lds
    buffer_load_dwordx4 v154, s[32:35], s58 offen offset:1024 lds
    s_waitcnt vmcnt(4)
    ds_read_b128 v[68:71], v9 offset:45056
    ds_read_b64_tr_b16 v[72:73], v159 offset:6144
    ds_read_b64_tr_b16 v[74:75], v159 offset:6656
    ds_read_b64_tr_b16 v[76:77], v160 offset:6144
    ds_read_b64_tr_b16 v[78:79], v160 offset:6656
    s_waitcnt lgkmcnt(5)
    v_mfma_f32_32x32x16_bf16 v[24:39], v[56:59], v[60:63], v[24:39]
    v_mfma_f32_32x32x16_bf16 v[40:55], v[56:59], v[64:67], v[40:55]
    s_add_u32 m0, s60, 4096
    s_add_u32 s58, s58, 49152
    buffer_load_dwordx4 v153, s[32:35], s58 offen lds
    buffer_load_dwordx4 v154, s[32:35], s58 offen offset:1024 lds
    s_waitcnt vmcnt(4)
    ds_read_b128 v[56:59], v8 offset:49152
    ds_read_b64_tr_b16 v[60:61], v159 offset:0
    ds_read_b64_tr_b16 v[62:63], v159 offset:512
    ds_read_b64_tr_b16 v[64:65], v160 offset:0
    ds_read_b64_tr_b16 v[66:67], v160 offset:512
    s_waitcnt lgkmcnt(5)
    v_mfma_f32_32x32x16_bf16 v[24:39], v[68:71], v[72:75], v[24:39]
    v_mfma_f32_32x32x16_bf16 v[40:55], v[68:71], v[76:79], v[40:55]
    s_add_u32 m0, s60, 6144
    s_add_u32 s58, s58, 49152
    buffer_load_dwordx4 v153, s[32:35], s58 offen lds
    buffer_load_dwordx4 v154, s[32:35], s58 offen offset:1024 lds
    s_waitcnt vmcnt(4)
    ds_read_b128 v[68:71], v9 offset:49152
    ds_read_b64_tr_b16 v[72:73], v159 offset:2048
    ds_read_b64_tr_b16 v[74:75], v159 offset:2560
    ds_read_b64_tr_b16 v[76:77], v160 offset:2048
    ds_read_b64_tr_b16 v[78:79], v160 offset:2560
    s_waitcnt lgkmcnt(5)
    v_mfma_f32_32x32x16_bf16 v[24:39], v[56:59], v[60:63], v[24:39]
    v_mfma_f32_32x32x16_bf16 v[40:55], v[56:59], v[64:67], v[40:55]
    s_add_u32 m0, s60, 0
    s_xor_b32 s58, s69, 7
    s_mul_i32 s58, s58, 196608
    s_add_u32 s58, s58, s59
    buffer_load_dwordx4 v153, s[32:35], s58 offen lds
    buffer_load_dwordx4 v154, s[32:35], s58 offen offset:1024 lds
    s_waitcnt vmcnt(4)
    ds_read_b128 v[56:59], v8 offset:53248
    ds_read_b64_tr_b16 v[60:61], v159 offset:4096
    ds_read_b64_tr_b16 v[62:63], v159 offset:4608
    ds_read_b64_tr_b16 v[64:65], v160 offset:4096
    ds_read_b64_tr_b16 v[66:67], v160 offset:4608
    s_waitcnt lgkmcnt(5)
    v_mfma_f32_32x32x16_bf16 v[24:39], v[68:71], v[72:75], v[24:39]
    v_mfma_f32_32x32x16_bf16 v[40:55], v[68:71], v[76:79], v[40:55]
    s_add_u32 m0, s60, 2048
    s_add_u32 s58, s58, 49152
    buffer_load_dwordx4 v153, s[32:35], s58 offen lds
    buffer_load_dwordx4 v154, s[32:35], s58 offen offset:1024 lds
    s_waitcnt vmcnt(4)
    ds_read_b128 v[68:71], v9 offset:53248
    ds_read_b64_tr_b16 v[72:73], v159 offset:6144
    ds_read_b64_tr_b16 v[74:75], v159 offset:6656
    ds_read_b64_tr_b16 v[76:77], v160 offset:6144
    ds_read_b64_tr_b16 v[78:79], v160 offset:6656
    s_waitcnt lgkmcnt(5)
    v_mfma_f32_32x32x16_bf16 v[24:39], v[56:59], v[60:63], v[24:39]
    v_mfma_f32_32x32x16_bf16 v[40:55], v[56:59], v[64:67], v[40:55]
    s_add_u32 m0, s60, 4096
    s_add_u32 s58, s58, 49152
    buffer_load_dwordx4 v153, s[32:35], s58 offen lds
    buffer_load_dwordx4 v154, s[32:35], s58 offen offset:1024 lds
    s_waitcnt vmcnt(4)
    ds_read_b128 v[56:59], v8 offset:57344
    ds_read_b64_tr_b16 v[60:61], v159 offset:0
    ds_read_b64_tr_b16 v[62:63], v159 offset:512
    ds_read_b64_tr_b16 v[64:65], v160 offset:0
    ds_read_b64_tr_b16 v[66:67], v160 offset:512
    s_waitcnt lgkmcnt(5)
    v_mfma_f32_32x32x16_bf16 v[24:39], v[68:71], v[72:75], v[24:39]
    v_mfma_f32_32x32x16_bf16 v[40:55], v[68:71], v[76:79], v[40:55]
    s_add_u32 m0, s60, 6144
    s_add_u32 s58, s58, 49152
    buffer_load_dwordx4 v153, s[32:35], s58 offen lds
    buffer_load_dwordx4 v154, s[32:35], s58 offen offset:1024 lds
    s_waitcnt vmcnt(4)
    ds_read_b128 v[68:71], v9 offset:57344
    ds_read_b64_tr_b16 v[72:73], v159 offset:2048
    ds_read_b64_tr_b16 v[74:75], v159 offset:2560
    ds_read_b64_tr_b16 v[76:77], v160 offset:2048
    ds_read_b64_tr_b16 v[78:79], v160 offset:2560
    s_waitcnt lgkmcnt(5)
    v_mfma_f32_32x32x16_bf16 v[24:39], v[56:59], v[60:63], v[24:39]
    v_mfma_f32_32x32x16_bf16 v[40:55], v[56:59], v[64:67], v[40:55]
    s_waitcnt vmcnt(2)
    ds_read_b128 v[56:59], v8 offset:61440
    ds_read_b64_tr_b16 v[60:61], v159 offset:4096
    ds_read_b64_tr_b16 v[62:63], v159 offset:4608
    ds_read_b64_tr_b16 v[64:65], v160 offset:4096
    ds_read_b64_tr_b16 v[66:67], v160 offset:4608
    s_waitcnt lgkmcnt(5)
    v_mfma_f32_32x32x16_bf16 v[24:39], v[68:71], v[72:75], v[24:39]
    v_mfma_f32_32x32x16_bf16 v[40:55], v[68:71], v[76:79], v[40:55]
    s_waitcnt vmcnt(0)
    ds_read_b128 v[68:71], v9 offset:61440
    ds_read_b64_tr_b16 v[72:73], v159 offset:6144
    ds_read_b64_tr_b16 v[74:75], v159 offset:6656
    ds_read_b64_tr_b16 v[76:77], v160 offset:6144
    ds_read_b64_tr_b16 v[78:79], v160 offset:6656
    s_waitcnt lgkmcnt(5)
    v_mfma_f32_32x32x16_bf16 v[24:39], v[56:59], v[60:63], v[24:39]
    v_mfma_f32_32x32x16_bf16 v[40:55], v[56:59], v[64:67], v[40:55]
    s_waitcnt lgkmcnt(0)
    v_mfma_f32_32x32x16_bf16 v[24:39], v[68:71], v[72:75], v[24:39]
    v_mfma_f32_32x32x16_bf16 v[40:55], v[68:71], v[76:79], v[40:55]
    s_branch L_kvend
L_a1:
    s_setprio 3
    v_lshrrev_b32 v2, 1, v1
    v_and_b32 v2, 3, v2
    v_bfe_u32 v3, v1, 4, 1
    v_xor_b32 v2, v2, v3
    v_lshlrev_b32 v2, 5, v2
    v_and_b32 v3, 1, v1
    v_lshl_add_u32 v2, v3, 4, v2
    v_lshrrev_b32 v3, 3, v1
    v_lshl_add_u32 v16, v3, 10, v2
    v_mul_u32_u24 v3, 3072, v3
    v_add_u32 v20, v3, v2
    v_xor_b32 v20, 64, v20
    v_add_u32 v17, 7168, v16
    v_add_u32 v21, 23552, v20
    v_add_u32 v18, 14336, v16
    v_add_u32 v22, 47104, v20
    v_add_u32 v19, 21504, v16
    v_add_u32 v23, 70656, v20
    s_lshl_b32 s57, s50, 7
    s_lshl_b32 s58, s3, 7
    s_waitcnt lgkmcnt(0)
    s_load_dword s4, s[98:99], 0
    s_mov_b32 s12, s84
    s_mov_b32 s13, s85
    s_mov_b32 s14, 0x80000
    s_mov_b32 s15, 0x20000
    s_mov_b32 s16, s78
    s_mov_b32 s17, s79
    s_mov_b32 s18, 0x180000
    s_mov_b32 s19, 0x20000
    s_xor_b32 s53, s69, 0
    s_lshl_b32 s54, s53, 16
    s_add_u32 s54, s54, s57
    s_mul_i32 s55, s53, 196608
    s_add_u32 s55, s55, s58
    s_mov_b32 m0, 16384
    s_nop 0
    buffer_load_dwordx4 v16, s[12:15], s54 offen offset:0 lds
    buffer_load_dwordx4 v17, s[12:15], s54 offen offset:1024 lds
    buffer_load_dwordx4 v18, s[12:15], s54 offen offset:2048 lds
    buffer_load_dwordx4 v19, s[12:15], s54 offen offset:3072 lds
    s_mov_b32 m0, 24576
    s_nop 0
    buffer_load_dwordx4 v20, s[16:19], s55 offen offset:0 lds
    buffer_load_dwordx4 v21, s[16:19], s55 offen offset:1024 lds
    buffer_load_dwordx4 v22, s[16:19], s55 offen offset:2048 lds
    buffer_load_dwordx4 v23, s[16:19], s55 offen offset:3072 lds
    s_mov_b32 m0, 20480
    s_add_u32 s54, s54, 32768
    buffer_load_dwordx4 v16, s[12:15], s54 offen offset:0 lds
    buffer_load_dwordx4 v17, s[12:15], s54 offen offset:1024 lds
    buffer_load_dwordx4 v18, s[12:15], s54 offen offset:2048 lds
    buffer_load_dwordx4 v19, s[12:15], s54 offen offset:3072 lds
    s_mov_b32 m0, 28672
    s_add_u32 s55, s55, 98304
    buffer_load_dwordx4 v20, s[16:19], s55 offen offset:0 lds
    buffer_load_dwordx4 v21, s[16:19], s55 offen offset:1024 lds
    buffer_load_dwordx4 v22, s[16:19], s55 offen offset:2048 lds
    buffer_load_dwordx4 v23, s[16:19], s55 offen offset:3072 lds
    s_xor_b32 s53, s69, 1
    s_lshl_b32 s54, s53, 16
    s_add_u32 s54, s54, s57
    s_mul_i32 s55, s53, 196608
    s_add_u32 s55, s55, s58
    s_mov_b32 m0, 32768
    s_nop 0
    buffer_load_dwordx4 v16, s[12:15], s54 offen offset:0 lds
    buffer_load_dwordx4 v17, s[12:15], s54 offen offset:1024 lds
    buffer_load_dwordx4 v18, s[12:15], s54 offen offset:2048 lds
    buffer_load_dwordx4 v19, s[12:15], s54 offen offset:3072 lds
    s_mov_b32 m0, 40960
    s_nop 0
    buffer_load_dwordx4 v20, s[16:19], s55 offen offset:0 lds
    buffer_load_dwordx4 v21, s[16:19], s55 offen offset:1024 lds
    buffer_load_dwordx4 v22, s[16:19], s55 offen offset:2048 lds
    buffer_load_dwordx4 v23, s[16:19], s55 offen offset:3072 lds
    s_mov_b32 m0, 36864
    s_add_u32 s54, s54, 32768
    buffer_load_dwordx4 v16, s[12:15], s54 offen offset:0 lds
    buffer_load_dwordx4 v17, s[12:15], s54 offen offset:1024 lds
    buffer_load_dwordx4 v18, s[12:15], s54 offen offset:2048 lds
    buffer_load_dwordx4 v19, s[12:15], s54 offen offset:3072 lds
    s_mov_b32 m0, 45056
    s_add_u32 s55, s55, 98304
    buffer_load_dwordx4 v20, s[16:19], s55 offen offset:0 lds
    buffer_load_dwordx4 v21, s[16:19], s55 offen offset:1024 lds
    buffer_load_dwordx4 v22, s[16:19], s55 offen offset:2048 lds
    buffer_load_dwordx4 v23, s[16:19], s55 offen offset:3072 lds
    s_mov_b32 s32, s78
    s_mov_b32 s33, s79
    s_mov_b32 s34, 0x180000
    s_mov_b32 s35, 0x20000
    s_mov_b32 s44, s98
    s_mov_b32 s45, s99
    s_mov_b32 s46, 0x1000000
    s_mov_b32 s47, 0x20000
    s_mov_b32 s64, 0xffff
    s_mov_b32 s65, 0xffff
    s_mov_b32 s70, 0x3fb8aa3b
    s_mov_b32 s71, 0x3fb8aa3b
    s_mov_b32 s20, 0x358637bd
    s_mov_b32 s21, 0x3f803f80
    v_lshrrev_b32 v2, 3, v1
    v_bfe_u32 v3, v1, 4, 1
    v_lshlrev_b32 v3, 2, v3
    v_xor_b32 v3, v3, v1
    v_and_b32 v3, 7, v3
    v_lshlrev_b32 v3, 4, v3
    v_mul_u32_u24 v2, 3072, v2
    v_add_u32 v153, v2, v3
    v_add_u32 v154, 23552, v153
    s_sub_u32 s27, s48, 8
    s_and_b32 s51, s27, 1
    s_lshl_b32 s60, s27, 13
    s_add_u32 s60, s60, 131072
    s_lshl_b32 s59, s23, 7
    s_cmp_lt_u32 s27, 2
    s_cselect_b32 s54, 2, 1
    s_cselect_b32 s55, 0, s20
    s_lshl_b32 s54, s54, 10
    s_add_u32 s59, s59, s54
    v_and_b32 v2, 31, v1
    v_lshrrev_b32 v3, 5, v1
    v_bfe_u32 v4, v1, 2, 2
    v_xor_b32 v4, v4, v3
    v_lshlrev_b32 v4, 4, v4
    v_lshl_add_u32 v5, v2, 6, v4
    s_lshl_b32 s53, s51, 11
    s_add_u32 s53, s53, 65536
    v_add_u32 v8, s53, v5
    v_xor_b32 v9, 32, v8
    v_lshlrev_b32 v2, 10, v3
    v_bfe_u32 v3, v1, 2, 2
    v_lshl_add_u32 v2, v3, 7, v2
    v_bfe_u32 v3, v1, 3, 1
    v_lshl_add_u32 v2, v3, 6, v2
    v_bfe_u32 v3, v1, 4, 1
    v_lshl_add_u32 v2, v3, 5, v2
    v_and_b32 v3, 3, v1
    v_lshl_add_u32 v2, v3, 3, v2
    v_add_u32 v159, s60, v2
    v_xor_b32 v160, 64, v159
    s_and_b32 s63, s2, 7
    s_lshl_b32 s63, s63, 3
    v_and_b32 v2, 15, v1
    v_lshlrev_b32 v2, 4, v2
    v_bfe_u32 v3, v1, 4, 1
    v_lshrrev_b32 v4, 5, v1
    v_lshl_add_u32 v12, v3, 9, v2
    v_lshl_add_u32 v12, v4, 3, v12
    v_lshl_add_u32 v155, v4, 8, v2
    v_lshl_add_u32 v155, v3, 3, v155
    s_lshl_b32 s7, s63, 12
    s_add_u32 s7, s7, 540672
    s_waitcnt lgkmcnt(0)
    s_mul_i32 s4, s4, 0x9e3779b1
    s_add_u32 s4, s4, 0x7f4a7c15
    v_mov_b32 v158, s4
    s_waitcnt vmcnt(16)
    s_barrier
    s_xor_b32 s53, s69, 2
    s_lshl_b32 s54, s53, 16
    s_add_u32 s54, s54, s57
    s_mul_i32 s55, s53, 196608
    s_add_u32 s55, s55, s58
    s_mov_b32 m0, 49152
    s_nop 0
    buffer_load_dwordx4 v16, s[12:15], s54 offen offset:0 lds
    buffer_load_dwordx4 v17, s[12:15], s54 offen offset:1024 lds
    buffer_load_dwordx4 v18, s[12:15], s54 offen offset:2048 lds
    buffer_load_dwordx4 v19, s[12:15], s54 offen offset:3072 lds
    s_mov_b32 m0, 57344
    s_nop 0
    buffer_load_dwordx4 v20, s[16:19], s55 offen offset:0 lds
    buffer_load_dwordx4 v21, s[16:19], s55 offen offset:1024 lds
    buffer_load_dwordx4 v22, s[16:19], s55 offen offset:2048 lds
    buffer_load_dwordx4 v23, s[16:19], s55 offen offset:3072 lds
    s_mov_b32 m0, 53248
    s_add_u32 s54, s54, 32768
    buffer_load_dwordx4 v16, s[12:15], s54 offen offset:0 lds
    buffer_load_dwordx4 v17, s[12:15], s54 offen offset:1024 lds
    buffer_load_dwordx4 v18, s[12:15], s54 offen offset:2048 lds
    buffer_load_dwordx4 v19, s[12:15], s54 offen offset:3072 lds
    s_mov_b32 m0, 61440
    s_add_u32 s55, s55, 98304
    buffer_load_dwordx4 v20, s[16:19], s55 offen offset:0 lds
    buffer_load_dwordx4 v21, s[16:19], s55 offen offset:1024 lds
    buffer_load_dwordx4 v22, s[16:19], s55 offen offset:2048 lds
    buffer_load_dwordx4 v23, s[16:19], s55 offen offset:3072 lds
    s_xor_b32 s53, s69, 3
    s_lshl_b32 s54, s53, 16
    s_add_u32 s54, s54, s57
    s_mul_i32 s55, s53, 196608
    s_add_u32 s55, s55, s58
    s_mov_b32 m0, 131072
    s_nop 0
    buffer_load_dwordx4 v16, s[12:15], s54 offen offset:0 lds
    buffer_load_dwordx4 v17, s[12:15], s54 offen offset:1024 lds
    buffer_load_dwordx4 v18, s[12:15], s54 offen offset:2048 lds
    buffer_load_dwordx4 v19, s[12:15], s54 offen offset:3072 lds
    s_mov_b32 m0, 139264
    s_nop 0
    buffer_load_dwordx4 v20, s[16:19], s55 offen offset:0 lds
    buffer_load_dwordx4 v21, s[16:19], s55 offen offset:1024 lds
    buffer_load_dwordx4 v22, s[16:19], s55 offen offset:2048 lds
    buffer_load_dwordx4 v23, s[16:19], s55 offen offset:3072 lds
    s_mov_b32 m0, 135168
    s_add_u32 s54, s54, 32768
    buffer_load_dwordx4 v16, s[12:15], s54 offen offset:0 lds
    buffer_load_dwordx4 v17, s[12:15], s54 offen offset:1024 lds
    buffer_load_dwordx4 v18, s[12:15], s54 offen offset:2048 lds
    buffer_load_dwordx4 v19, s[12:15], s54 offen offset:3072 lds
    s_mov_b32 m0, 143360
    s_add_u32 s55, s55, 98304
    buffer_load_dwordx4 v20, s[16:19], s55 offen offset:0 lds
    buffer_load_dwordx4 v21, s[16:19], s55 offen offset:1024 lds
    buffer_load_dwordx4 v22, s[16:19], s55 offen offset:2048 lds
    buffer_load_dwordx4 v23, s[16:19], s55 offen offset:3072 lds
    s_waitcnt vmcnt(32)
    s_barrier
    s_xor_b32 s53, s69, 4
    s_lshl_b32 s54, s53, 16
    s_add_u32 s54, s54, s57
    s_mul_i32 s55, s53, 196608
    s_add_u32 s55, s55, s58
    s_mov_b32 m0, 16384
    s_nop 0
    buffer_load_dwordx4 v16, s[12:15], s54 offen offset:0 lds
    buffer_load_dwordx4 v17, s[12:15], s54 offen offset:1024 lds
    buffer_load_dwordx4 v18, s[12:15], s54 offen offset:2048 lds
    buffer_load_dwordx4 v19, s[12:15], s54 offen offset:3072 lds
    s_mov_b32 m0, 24576
    s_nop 0
    buffer_load_dwordx4 v20, s[16:19], s55 offen offset:0 lds
    buffer_load_dwordx4 v21, s[16:19], s55 offen offset:1024 lds
    buffer_load_dwordx4 v22, s[16:19], s55 offen offset:2048 lds
    buffer_load_dwordx4 v23, s[16:19], s55 offen offset:3072 lds
    s_mov_b32 m0, 20480
    s_add_u32 s54, s54, 32768
    buffer_load_dwordx4 v16, s[12:15], s54 offen offset:0 lds
    buffer_load_dwordx4 v17, s[12:15], s54 offen offset:1024 lds
    buffer_load_dwordx4 v18, s[12:15], s54 offen offset:2048 lds
    buffer_load_dwordx4 v19, s[12:15], s54 offen offset:3072 lds
    s_mov_b32 m0, 28672
    s_add_u32 s55, s55, 98304
    buffer_load_dwordx4 v20, s[16:19], s55 offen offset:0 lds
    buffer_load_dwordx4 v21, s[16:19], s55 offen offset:1024 lds
    buffer_load_dwordx4 v22, s[16:19], s55 offen offset:2048 lds
    buffer_load_dwordx4 v23, s[16:19], s55 offen offset:3072 lds
    s_waitcnt vmcnt(32)
    s_barrier
    s_xor_b32 s53, s69, 5
    s_lshl_b32 s54, s53, 16
    s_add_u32 s54, s54, s57
    s_mul_i32 s55, s53, 196608
    s_add_u32 s55, s55, s58
    s_mov_b32 m0, 32768
    s_nop 0
    buffer_load_dwordx4 v16, s[12:15], s54 offen offset:0 lds
    buffer_load_dwordx4 v17, s[12:15], s54 offen offset:1024 lds
    buffer_load_dwordx4 v18, s[12:15], s54 offen offset:2048 lds
    buffer_load_dwordx4 v19, s[12:15], s54 offen offset:3072 lds
    s_mov_b32 m0, 40960
    s_nop 0
    buffer_load_dwordx4 v20, s[16:19], s55 offen offset:0 lds
    buffer_load_dwordx4 v21, s[16:19], s55 offen offset:1024 lds
    buffer_load_dwordx4 v22, s[16:19], s55 offen offset:2048 lds
    buffer_load_dwordx4 v23, s[16:19], s55 offen offset:3072 lds
    s_mov_b32 m0, 36864
    s_add_u32 s54, s54, 32768
    buffer_load_dwordx4 v16, s[12:15], s54 offen offset:0 lds
    buffer_load_dwordx4 v17, s[12:15], s54 offen offset:1024 lds
    buffer_load_dwordx4 v18, s[12:15], s54 offen offset:2048 lds
    buffer_load_dwordx4 v19, s[12:15], s54 offen offset:3072 lds
    s_mov_b32 m0, 45056
    s_add_u32 s55, s55, 98304
    buffer_load_dwordx4 v20, s[16:19], s55 offen offset:0 lds
    buffer_load_dwordx4 v21, s[16:19], s55 offen offset:1024 lds
    buffer_load_dwordx4 v22, s[16:19], s55 offen offset:2048 lds
    buffer_load_dwordx4 v23, s[16:19], s55 offen offset:3072 lds
    s_waitcnt vmcnt(32)
    s_barrier
    s_xor_b32 s53, s69, 6
    s_lshl_b32 s54, s53, 16
    s_add_u32 s54, s54, s57
    s_mul_i32 s55, s53, 196608
    s_add_u32 s55, s55, s58
    s_mov_b32 m0, 49152
    s_nop 0
    buffer_load_dwordx4 v16, s[12:15], s54 offen offset:0 lds
    buffer_load_dwordx4 v17, s[12:15], s54 offen offset:1024 lds
    buffer_load_dwordx4 v18, s[12:15], s54 offen offset:2048 lds
    buffer_load_dwordx4 v19, s[12:15], s54 offen offset:3072 lds
    s_mov_b32 m0, 57344
    s_nop 0
    buffer_load_dwordx4 v20, s[16:19], s55 offen offset:0 lds
    buffer_load_dwordx4 v21, s[16:19], s55 offen offset:1024 lds
    buffer_load_dwordx4 v22, s[16:19], s55 offen offset:2048 lds
    buffer_load_dwordx4 v23, s[16:19], s55 offen offset:3072 lds
    s_mov_b32 m0, 53248
    s_add_u32 s54, s54, 32768
    buffer_load_dwordx4 v16, s[12:15], s54 offen offset:0 lds
    buffer_load_dwordx4 v17, s[12:15], s54 offen offset:1024 lds
    buffer_load_dwordx4 v18, s[12:15], s54 offen offset:2048 lds
    buffer_load_dwordx4 v19, s[12:15], s54 offen offset:3072 lds
    s_mov_b32 m0, 61440
    s_add_u32 s55, s55, 98304
    buffer_load_dwordx4 v20, s[16:19], s55 offen offset:0 lds
    buffer_load_dwordx4 v21, s[16:19], s55 offen offset:1024 lds
    buffer_load_dwordx4 v22, s[16:19], s55 offen offset:2048 lds
    buffer_load_dwordx4 v23, s[16:19], s55 offen offset:3072 lds
    s_waitcnt vmcnt(32)
    s_barrier
    s_xor_b32 s53, s69, 7
    s_lshl_b32 s54, s53, 16
    s_add_u32 s54, s54, s57
    s_mul_i32 s55, s53, 196608
    s_add_u32 s55, s55, s58
    s_mov_b32 m0, 131072
    s_nop 0
    buffer_load_dwordx4 v16, s[12:15], s54 offen offset:0 lds
    buffer_load_dwordx4 v17, s[12:15], s54 offen offset:1024 lds
    buffer_load_dwordx4 v18, s[12:15], s54 offen offset:2048 lds
    buffer_load_dwordx4 v19, s[12:15], s54 offen offset:3072 lds
    s_mov_b32 m0, 139264
    s_nop 0
    buffer_load_dwordx4 v20, s[16:19], s55 offen offset:0 lds
    buffer_load_dwordx4 v21, s[16:19], s55 offen offset:1024 lds
    buffer_load_dwordx4 v22, s[16:19], s55 offen offset:2048 lds
    buffer_load_dwordx4 v23, s[16:19], s55 offen offset:3072 lds
    s_mov_b32 m0, 135168
    s_add_u32 s54, s54, 32768
    buffer_load_dwordx4 v16, s[12:15], s54 offen offset:0 lds
    buffer_load_dwordx4 v17, s[12:15], s54 offen offset:1024 lds
    buffer_load_dwordx4 v18, s[12:15], s54 offen offset:2048 lds
    buffer_load_dwordx4 v19, s[12:15], s54 offen offset:3072 lds
    s_mov_b32 m0, 143360
    s_add_u32 s55, s55, 98304
    buffer_load_dwordx4 v20, s[16:19], s55 offen offset:0 lds
    buffer_load_dwordx4 v21, s[16:19], s55 offen offset:1024 lds
    buffer_load_dwordx4 v22, s[16:19], s55 offen offset:2048 lds
    buffer_load_dwordx4 v23, s[16:19], s55 offen offset:3072 lds
    s_waitcnt vmcnt(32)
    s_barrier
    s_waitcnt vmcnt(16)
    s_barrier
    s_add_u32 s53, s7, 0
    buffer_load_dwordx4 v[80:83], v11, s[44:47], s53 offen offset:0 sc1
    buffer_load_dwordx4 v[84:87], v11, s[44:47], s53 offen offset:1024 sc1
    buffer_load_dwordx4 v[88:91], v11, s[44:47], s53 offen offset:2048 sc1
    buffer_load_dwordx4 v[92:95], v11, s[44:47], s53 offen offset:3072 sc1
    s_add_u32 s53, s7, 4096
    buffer_load_dwordx4 v[96:99], v11, s[44:47], s53 offen offset:0 sc1
    buffer_load_dwordx4 v[100:103], v11, s[44:47], s53 offen offset:1024 sc1
    buffer_load_dwordx4 v[104:107], v11, s[44:47], s53 offen offset:2048 sc1
    buffer_load_dwordx4 v[108:111], v11, s[44:47], s53 offen offset:3072 sc1
    s_add_u32 s53, s7, 8192
    buffer_load_dwordx4 v[112:115], v11, s[44:47], s53 offen offset:0 sc1
    buffer_load_dwordx4 v[116:119], v11, s[44:47], s53 offen offset:1024 sc1
    buffer_load_dwordx4 v[120:123], v11, s[44:47], s53 offen offset:2048 sc1
    buffer_load_dwordx4 v[124:127], v11, s[44:47], s53 offen offset:3072 sc1
    s_add_u32 s53, s7, 12288
    buffer_load_dwordx4 v[128:131], v11, s[44:47], s53 offen offset:0 sc1
    buffer_load_dwordx4 v[132:135], v11, s[44:47], s53 offen offset:1024 sc1
    buffer_load_dwordx4 v[136:139], v11, s[44:47], s53 offen offset:2048 sc1
    buffer_load_dwordx4 v[140:143], v11, s[44:47], s53 offen offset:3072 sc1
    s_waitcnt vmcnt(16)
    s_barrier
    s_mov_b32 s62, 0
L_tg1_loop:
    s_waitcnt vmcnt(0)
    v_min3_u32 v2, v158, v81, v83
    v_max3_u32 v3, v158, v81, v83
    v_min3_u32 v2, v2, v85, v87
    v_max3_u32 v3, v3, v85, v87
    v_min3_u32 v2, v2, v89, v91
    v_max3_u32 v3, v3, v89, v91
    v_min3_u32 v2, v2, v93, v95
    v_max3_u32 v3, v3, v93, v95
    v_min3_u32 v2, v2, v97, v99
    v_max3_u32 v3, v3, v97, v99
    v_min3_u32 v2, v2, v101, v103
    v_max3_u32 v3, v3, v101, v103
    v_min3_u32 v2, v2, v105, v107
    v_max3_u32 v3, v3, v105, v107
    v_min3_u32 v2, v2, v109, v111
    v_max3_u32 v3, v3, v109, v111
    v_min3_u32 v2, v2, v113, v115
    v_max3_u32 v3, v3, v113, v115
    v_min3_u32 v2, v2, v117, v119
    v_max3_u32 v3, v3, v117, v119
    v_min3_u32 v2, v2, v121, v123
    v_max3_u32 v3, v3, v121, v123
    v_min3_u32 v2, v2, v125, v127
    v_max3_u32 v3, v3, v125, v127
    v_min3_u32 v2, v2, v129, v131
    v_max3_u32 v3, v3, v129, v131
    v_min3_u32 v2, v2, v133, v135
    v_max3_u32 v3, v3, v133, v135
    v_min3_u32 v2, v2, v137, v139
    v_max3_u32 v3, v3, v137, v139
    v_min3_u32 v2, v2, v141, v143
    v_max3_u32 v3, v3, v141, v143
    v_cmp_ne_u32 vcc, v2, v3
    s_cbranch_vccz L_tg1_ok
    s_add_u32 s62, s62, 1
    s_cmp_ge_u32 s62, 100000
    s_cbranch_scc1 L_tg1_ok
    s_add_u32 s53, s7, 0
    buffer_load_dwordx4 v[80:83], v11, s[44:47], s53 offen offset:0 sc1
    buffer_load_dwordx4 v[84:87], v11, s[44:47], s53 offen offset:1024 sc1
    buffer_load_dwordx4 v[88:91], v11, s[44:47], s53 offen offset:2048 sc1
    buffer_load_dwordx4 v[92:95], v11, s[44:47], s53 offen offset:3072 sc1
    s_add_u32 s53, s7, 4096
    buffer_load_dwordx4 v[96:99], v11, s[44:47], s53 offen offset:0 sc1
    buffer_load_dwordx4 v[100:103], v11, s[44:47], s53 offen offset:1024 sc1
    buffer_load_dwordx4 v[104:107], v11, s[44:47], s53 offen offset:2048 sc1
    buffer_load_dwordx4 v[108:111], v11, s[44:47], s53 offen offset:3072 sc1
    s_add_u32 s53, s7, 8192
    buffer_load_dwordx4 v[112:115], v11, s[44:47], s53 offen offset:0 sc1
    buffer_load_dwordx4 v[116:119], v11, s[44:47], s53 offen offset:1024 sc1
    buffer_load_dwordx4 v[120:123], v11, s[44:47], s53 offen offset:2048 sc1
    buffer_load_dwordx4 v[124:127], v11, s[44:47], s53 offen offset:3072 sc1
    s_add_u32 s53, s7, 12288
    buffer_load_dwordx4 v[128:131], v11, s[44:47], s53 offen offset:0 sc1
    buffer_load_dwordx4 v[132:135], v11, s[44:47], s53 offen offset:1024 sc1
    buffer_load_dwordx4 v[136:139], v11, s[44:47], s53 offen offset:2048 sc1
    buffer_load_dwordx4 v[140:143], v11, s[44:47], s53 offen offset:3072 sc1
    s_branch L_tg1_loop
L_tg1_ok:
    v_mov_b32 v81, v82
    v_mov_b32 v85, v86
    v_mov_b32 v89, v90
    v_mov_b32 v93, v94
    ds_write_b64 v12, v[80:81] offset:8192
    ds_write_b64 v155, v[84:85] offset:9216
    ds_write_b64 v12, v[88:89] offset:8448
    ds_write_b64 v155, v[92:93] offset:9728
    v_mov_b32 v97, v98
    v_mov_b32 v101, v102
    v_mov_b32 v105, v106
    v_mov_b32 v109, v110
    ds_write_b64 v12, v[96:97] offset:10240
    ds_write_b64 v155, v[100:101] offset:11264
    ds_write_b64 v12, v[104:105] offset:10496
    ds_write_b64 v155, v[108:109] offset:11776
    v_mov_b32 v113, v114
    v_mov_b32 v117, v118
    v_mov_b32 v121, v122
    v_mov_b32 v125, v126
    ds_write_b64 v12, v[112:113] offset:12288
    ds_write_b64 v155, v[116:117] offset:13312
    ds_write_b64 v12, v[120:121] offset:12544
    ds_write_b64 v155, v[124:125] offset:13824
    v_mov_b32 v129, v130
    v_mov_b32 v133, v134
    v_mov_b32 v137, v138
    v_mov_b32 v141, v142
    s_waitcnt lgkmcnt(8)
    ds_write_b64 v12, v[128:129] offset:14336
    ds_write_b64 v155, v[132:133] offset:15360
    ds_write_b64 v12, v[136:137] offset:14592
    ds_write_b64 v155, v[140:141] offset:15872
    s_waitcnt lgkmcnt(0)
    s_barrier
    s_branch L_kv01
L_a23:
    s_setprio 3
    s_sub_u32 s54, s48, 8
    s_lshl_b32 s55, s54, 8
    s_xor_b32 s53, s53, s55
    s_lshl_b32 s54, s54, 14
    s_add_u32 s54, s54, 65536
    s_waitcnt lgkmcnt(0)
    s_mov_b32 s8, s76
    s_mov_b32 s9, s77
    s_load_dword s4, s[98:99], 0
    s_waitcnt lgkmcnt(0)
    s_mul_i32 s4, s4, 0x9e3779b1
    s_add_u32 s4, s4, 0x7f4a7c15
    v_mov_b32 v158, s4
    s_add_u32 s56, s22, 1
    s_and_b32 s56, s56, 3
    s_lshl_b32 s55, s56, 10
    s_add_u32 s57, s55, s54
    s_lshl_b32 s55, s56, 14
    s_add_u32 s58, s55, s53
    s_barrier
    s_add_u32 m0, s57, 0
    s_nop 0
    buffer_load_dwordx4 v6, s[8:11], s58 offen offset:0 lds
    s_add_u32 m0, s57, 4032
    s_nop 0
    buffer_load_dwordx4 v6, s[8:11], s58 offen offset:64 lds
    s_add_u32 m0, s57, 8192
    s_xor_b32 s58, s58, 128
    buffer_load_dwordx4 v6, s[8:11], s58 offen offset:0 lds
    s_add_u32 m0, s57, 12224
    s_nop 0
    buffer_load_dwordx4 v6, s[8:11], s58 offen offset:64 lds
    s_add_u32 s56, s22, 2
    s_and_b32 s56, s56, 3
    s_lshl_b32 s55, s56, 10
    s_add_u32 s57, s55, s54
    s_lshl_b32 s55, s56, 14
    s_add_u32 s58, s55, s53
    s_barrier
    s_add_u32 m0, s57, 0
    s_nop 0
    buffer_load_dwordx4 v6, s[8:11], s58 offen offset:0 lds
    s_add_u32 m0, s57, 4032
    s_nop 0
    buffer_load_dwordx4 v6, s[8:11], s58 offen offset:64 lds
    s_add_u32 m0, s57, 8192
    s_xor_b32 s58, s58, 128
    buffer_load_dwordx4 v6, s[8:11], s58 offen offset:0 lds
    s_add_u32 m0, s57, 12224
    s_nop 0
    buffer_load_dwordx4 v6, s[8:11], s58 offen offset:64 lds
    s_mov_b32 s32, s78
    s_mov_b32 s33, s79
    s_mov_b32 s34, 0x180000
    s_mov_b32 s35, 0x20000
    v_lshrrev_b32 v2, 3, v1
    v_mul_u32_u24 v2, 3072, v2
    v_and_b32 v3, 7, v1
    v_lshl_add_u32 v2, v3, 7, v2
    s_mul_i32 s55, s2, 6144
    s_sub_u32 s56, s48, 9
    s_lshl_b32 s56, s56, 10
    s_add_u32 s55, s55, s56
    s_mov_b64 exec, 0xffff
    buffer_load_dword v157, v2, s[32:35], s55 offen
    s_mov_b64 exec, -1
    s_add_u32 s56, s22, 3
    s_and_b32 s56, s56, 3
    s_lshl_b32 s55, s56, 10
    s_add_u32 s57, s55, s54
    s_lshl_b32 s55, s56, 14
    s_add_u32 s58, s55, s53
    s_barrier
    s_add_u32 m0, s57, 0
    s_nop 0
    buffer_load_dwordx4 v6, s[8:11], s58 offen offset:0 lds
    s_add_u32 m0, s57, 4032
    s_nop 0
    buffer_load_dwordx4 v6, s[8:11], s58 offen offset:64 lds
    s_add_u32 m0, s57, 8192
    s_xor_b32 s58, s58, 128
    buffer_load_dwordx4 v6, s[8:11], s58 offen offset:0 lds
    s_add_u32 m0, s57, 12224
    s_nop 0
    buffer_load_dwordx4 v6, s[8:11], s58 offen offset:64 lds
    s_mov_b32 s32, s78
    s_mov_b32 s33, s79
    s_mov_b32 s34, 0x180000
    s_mov_b32 s35, 0x20000
    s_mov_b32 s44, s98
    s_mov_b32 s45, s99
    s_mov_b32 s46, 0x1000000
    s_mov_b32 s47, 0x20000
    s_mov_b32 s64, 0xffff
    s_mov_b32 s65, 0xffff
    s_mov_b32 s70, 0x3fb8aa3b
    s_mov_b32 s71, 0x3fb8aa3b
    s_mov_b32 s20, 0x358637bd
    s_mov_b32 s21, 0x3f803f80
    v_lshrrev_b32 v2, 3, v1
    v_bfe_u32 v3, v1, 4, 1
    v_lshlrev_b32 v3, 2, v3
    v_xor_b32 v3, v3, v1
    v_and_b32 v3, 7, v3
    v_lshlrev_b32 v3, 4, v3
    v_mul_u32_u24 v2, 3072, v2
    v_add_u32 v153, v2, v3
    v_add_u32 v154, 23552, v153
    s_sub_u32 s27, s48, 8
    s_and_b32 s51, s27, 1
    s_lshl_b32 s60, s27, 13
    s_add_u32 s60, s60, 131072
    s_lshl_b32 s59, s23, 7
    s_cmp_lt_u32 s27, 2
    s_cselect_b32 s54, 2, 1
    s_cselect_b32 s55, 0, s20
    s_lshl_b32 s54, s54, 10
    s_add_u32 s59, s59, s54
    v_mov_b32 v24, s55
    v_mov_b32 v25, s55
    v_mov_b32 v26, s55
    v_mov_b32 v27, s55
    v_mov_b32 v28, s55
    v_mov_b32 v29, s55
    v_mov_b32 v30, s55
    v_mov_b32 v31, s55
    v_mov_b32 v32, s55
    v_mov_b32 v33, s55
    v_mov_b32 v34, s55
    v_mov_b32 v35, s55
    v_mov_b32 v36, s55
    v_mov_b32 v37, s55
    v_mov_b32 v38, s55
    v_mov_b32 v39, s55
    v_mov_b32 v40, s55
    v_mov_b32 v41, s55
    v_mov_b32 v42, s55
    v_mov_b32 v43, s55
    v_mov_b32 v44, s55
    v_mov_b32 v45, s55
    v_mov_b32 v46, s55
    v_mov_b32 v47, s55
    v_mov_b32 v48, s55
    v_mov_b32 v49, s55
    v_mov_b32 v50, s55
    v_mov_b32 v51, s55
    v_mov_b32 v52, s55
    v_mov_b32 v53, s55
    v_mov_b32 v54, s55
    v_mov_b32 v55, s55
    v_and_b32 v2, 31, v1
    v_lshrrev_b32 v3, 5, v1
    v_bfe_u32 v4, v1, 2, 2
    v_xor_b32 v4, v4, v3
    v_lshlrev_b32 v4, 4, v4
    v_lshl_add_u32 v5, v2, 6, v4
    s_lshl_b32 s53, s51, 11
    s_add_u32 s53, s53, 65536
    v_add_u32 v8, s53, v5
    v_xor_b32 v9, 32, v8
    v_lshlrev_b32 v2, 10, v3
    v_bfe_u32 v3, v1, 2, 2
    v_lshl_add_u32 v2, v3, 7, v2
    v_bfe_u32 v3, v1, 3, 1
    v_lshl_add_u32 v2, v3, 6, v2
    v_bfe_u32 v3, v1, 4, 1
    v_lshl_add_u32 v2, v3, 5, v2
    v_and_b32 v3, 3, v1
    v_lshl_add_u32 v2, v3, 3, v2
    v_add_u32 v159, s60, v2
    v_xor_b32 v160, 64, v159
    s_and_b32 s63, s2, 7
    s_lshl_b32 s63, s63, 3
    v_add_u32 v152, s63, v1
    v_and_b32 v152, 63, v152
    v_lshlrev_b32 v152, 4, v152
    s_barrier
    s_waitcnt vmcnt(0)
    s_barrier
    s_barrier
    s_add_u32 m0, s60, 0
    s_xor_b32 s58, s69, 0
    s_mul_i32 s58, s58, 196608
    s_add_u32 s58, s58, s59
    buffer_load_dwordx4 v153, s[32:35], s58 offen lds
    buffer_load_dwordx4 v154, s[32:35], s58 offen offset:1024 lds
    s_add_u32 m0, s60, 2048
    s_add_u32 s58, s58, 49152
    buffer_load_dwordx4 v153, s[32:35], s58 offen lds
    buffer_load_dwordx4 v154, s[32:35], s58 offen offset:1024 lds
    s_add_u32 m0, s60, 4096
    s_add_u32 s58, s58, 49152
    buffer_load_dwordx4 v153, s[32:35], s58 offen lds
    buffer_load_dwordx4 v154, s[32:35], s58 offen offset:1024 lds
    s_add_u32 m0, s60, 6144
    s_add_u32 s58, s58, 49152
    buffer_load_dwordx4 v153, s[32:35], s58 offen lds
    buffer_load_dwordx4 v154, s[32:35], s58 offen offset:1024 lds
    s_barrier
    s_waitcnt vmcnt(6)
    ds_read_b128 v[56:59], v8 offset:0
    ds_read_b64_tr_b16 v[60:61], v159 offset:0
    ds_read_b64_tr_b16 v[62:63], v159 offset:512
    ds_read_b64_tr_b16 v[64:65], v160 offset:0
    ds_read_b64_tr_b16 v[66:67], v160 offset:512
    s_waitcnt vmcnt(4)
    s_barrier
    ds_read_b128 v[68:71], v9 offset:0
    ds_read_b64_tr_b16 v[72:73], v159 offset:2048
    ds_read_b64_tr_b16 v[74:75], v159 offset:2560
    ds_read_b64_tr_b16 v[76:77], v160 offset:2048
    ds_read_b64_tr_b16 v[78:79], v160 offset:2560
    s_waitcnt lgkmcnt(5)
    v_mfma_f32_32x32x16_bf16 v[24:39], v[56:59], v[60:63], v[24:39]
    v_mfma_f32_32x32x16_bf16 v[40:55], v[56:59], v[64:67], v[40:55]
    s_add_u32 m0, s60, 0
    s_xor_b32 s58, s69, 1
    s_mul_i32 s58, s58, 196608
    s_add_u32 s58, s58, s59
    buffer_load_dwordx4 v153, s[32:35], s58 offen lds
    buffer_load_dwordx4 v154, s[32:35], s58 offen offset:1024 lds
    s_waitcnt vmcnt(4)
    ds_read_b128 v[56:59], v8 offset:4096
    ds_read_b64_tr_b16 v[60:61], v159 offset:4096
    ds_read_b64_tr_b16 v[62:63], v159 offset:4608
    ds_read_b64_tr_b16 v[64:65], v160 offset:4096
    ds_read_b64_tr_b16 v[66:67], v160 offset:4608
    s_waitcnt lgkmcnt(5)
    v_mfma_f32_32x32x16_bf16 v[24:39], v[68:71], v[72:75], v[24:39]
    v_mfma_f32_32x32x16_bf16 v[40:55], v[68:71], v[76:79], v[40:55]
    s_add_u32 m0, s60, 2048
    s_add_u32 s58, s58, 49152
    buffer_load_dwordx4 v153, s[32:35], s58 offen lds
    buffer_load_dwordx4 v154, s[32:35], s58 offen offset:1024 lds
    s_waitcnt vmcnt(4)
    ds_read_b128 v[68:71], v9 offset:4096
    ds_read_b64_tr_b16 v[72:73], v159 offset:6144
    ds_read_b64_tr_b16 v[74:75], v159 offset:6656
    ds_read_b64_tr_b16 v[76:77], v160 offset:6144
    ds_read_b64_tr_b16 v[78:79], v160 offset:6656
    s_waitcnt lgkmcnt(5)
    v_mfma_f32_32x32x16_bf16 v[24:39], v[56:59], v[60:63], v[24:39]
    v_mfma_f32_32x32x16_bf16 v[40:55], v[56:59], v[64:67], v[40:55]
    s_add_u32 m0, s60, 4096
    s_add_u32 s58, s58, 49152
    buffer_load_dwordx4 v153, s[32:35], s58 offen lds
    buffer_load_dwordx4 v154, s[32:35], s58 offen offset:1024 lds
    s_waitcnt vmcnt(4)
    ds_read_b128 v[56:59], v8 offset:8192
    ds_read_b64_tr_b16 v[60:61], v159 offset:0
    ds_read_b64_tr_b16 v[62:63], v159 offset:512
    ds_read_b64_tr_b16 v[64:65], v160 offset:0
    ds_read_b64_tr_b16 v[66:67], v160 offset:512
    s_waitcnt lgkmcnt(5)
    v_mfma_f32_32x32x16_bf16 v[24:39], v[68:71], v[72:75], v[24:39]
    v_mfma_f32_32x32x16_bf16 v[40:55], v[68:71], v[76:79], v[40:55]
    s_add_u32 m0, s60, 6144
    s_add_u32 s58, s58, 49152
    buffer_load_dwordx4 v153, s[32:35], s58 offen lds
    buffer_load_dwordx4 v154, s[32:35], s58 offen offset:1024 lds
    s_waitcnt vmcnt(4)
    ds_read_b128 v[68:71], v9 offset:8192
    ds_read_b64_tr_b16 v[72:73], v159 offset:2048
    ds_read_b64_tr_b16 v[74:75], v159 offset:2560
    ds_read_b64_tr_b16 v[76:77], v160 offset:2048
    ds_read_b64_tr_b16 v[78:79], v160 offset:2560
    s_waitcnt lgkmcnt(5)
    v_mfma_f32_32x32x16_bf16 v[24:39], v[56:59], v[60:63], v[24:39]
    v_mfma_f32_32x32x16_bf16 v[40:55], v[56:59], v[64:67], v[40:55]
    s_add_u32 m0, s60, 0
    s_xor_b32 s58, s69, 2
    s_mul_i32 s58, s58, 196608
    s_add_u32 s58, s58, s59
    buffer_load_dwordx4 v153, s[32:35], s58 offen lds
    buffer_load_dwordx4 v154, s[32:35], s58 offen offset:1024 lds
    s_waitcnt vmcnt(4)
    s_barrier
    buffer_load_dwordx4 v[148:151], v152, s[44:47], 0 offen offset:1024 sc1
    s_waitcnt vmcnt(0)
    s_mov_b32 s62, 0
L_skvB_loop:
    v_cmp_ne_u32 vcc, v148, v158
    v_cmp_ne_u32 s[40:41], v149, v158
    s_or_b64 vcc, vcc, s[40:41]
    v_cmp_ne_u32 s[40:41], v150, v158
    s_or_b64 vcc, vcc, s[40:41]
    v_cmp_ne_u32 s[40:41], v151, v158
    s_or_b64 vcc, vcc, s[40:41]
    s_cmp_eq_u64 vcc, 0
    s_cbranch_scc1 L_skvB_ok
    s_add_u32 s62, s62, 1
    s_cmp_ge_u32 s62, 100000
    s_cbranch_scc1 L_skvB_ok
    buffer_load_dwordx4 v[148:151], v152, s[44:47], 0 offen offset:1024 sc1
    s_waitcnt vmcnt(0)
    s_branch L_skvB_loop
L_skvB_ok:
    s_mul_i32 s53, s51, 12
    s_add_u32 s53, s53, 8
    s_add_u32 s55, s53, 12
L_kvdB:
    s_add_u32 s54, s53, s63
    s_and_b32 s54, s54, 63
    s_lshl_b32 s54, s54, 11
    s_add_u32 s54, s54, 131072
    s_lshl_b32 m0, s53, 11
    s_waitcnt vmcnt(40)
    buffer_load_dwordx4 v11, s[44:47], s54 offen offset:0 sc1 lds
    buffer_load_dwordx4 v11, s[44:47], s54 offen offset:1024 sc1 lds
    buffer_load_dwordx4 v11, s[44:47], s54 offen offset:2048 sc1 lds
    buffer_load_dwordx4 v11, s[44:47], s54 offen offset:3072 sc1 lds
    s_add_u32 m0, m0, 4096
    s_add_u32 s54, s54, 4096
    buffer_load_dwordx4 v11, s[44:47], s54 offen offset:0 sc1 lds
    buffer_load_dwordx4 v11, s[44:47], s54 offen offset:1024 sc1 lds
    buffer_load_dwordx4 v11, s[44:47], s54 offen offset:2048 sc1 lds
    buffer_load_dwordx4 v11, s[44:47], s54 offen offset:3072 sc1 lds
    s_add_u32 s53, s53, 4
    s_cmp_lt_u32 s53, s55
    s_cbranch_scc1 L_kvdB
    s_or_b32 s53, s2, s51
    s_cmp_lg_u32 s53, 0
    s_cbranch_scc1 L_noep
    s_mov_b32 s53, 0
    s_mov_b64 exec, 1
    buffer_store_dword v158, v156, s[44:47], s53 offen sc1
    s_mov_b64 exec, -1
L_noep:
    ds_read_b128 v[56:59], v8 offset:12288
    ds_read_b64_tr_b16 v[60:61], v159 offset:4096
    ds_read_b64_tr_b16 v[62:63], v159 offset:4608
    ds_read_b64_tr_b16 v[64:65], v160 offset:4096
    ds_read_b64_tr_b16 v[66:67], v160 offset:4608
    s_waitcnt lgkmcnt(5)
    v_mfma_f32_32x32x16_bf16 v[24:39], v[68:71], v[72:75], v[24:39]
    v_mfma_f32_32x32x16_bf16 v[40:55], v[68:71], v[76:79], v[40:55]
    s_add_u32 m0, s60, 2048
    s_add_u32 s58, s58, 49152
    buffer_load_dwordx4 v153, s[32:35], s58 offen lds
    buffer_load_dwordx4 v154, s[32:35], s58 offen offset:1024 lds
    ds_read_b128 v[68:71], v9 offset:12288
    ds_read_b64_tr_b16 v[72:73], v159 offset:6144
    ds_read_b64_tr_b16 v[74:75], v159 offset:6656
    ds_read_b64_tr_b16 v[76:77], v160 offset:6144
    ds_read_b64_tr_b16 v[78:79], v160 offset:6656
    s_waitcnt lgkmcnt(5)
    v_mfma_f32_32x32x16_bf16 v[24:39], v[56:59], v[60:63], v[24:39]
    v_mfma_f32_32x32x16_bf16 v[40:55], v[56:59], v[64:67], v[40:55]
    s_add_u32 m0, s60, 4096
    s_add_u32 s58, s58, 49152
    buffer_load_dwordx4 v153, s[32:35], s58 offen lds
    buffer_load_dwordx4 v154, s[32:35], s58 offen offset:1024 lds
    ds_read_b128 v[56:59], v8 offset:16384
    ds_read_b64_tr_b16 v[60:61], v159 offset:0
    ds_read_b64_tr_b16 v[62:63], v159 offset:512
    ds_read_b64_tr_b16 v[64:65], v160 offset:0
    ds_read_b64_tr_b16 v[66:67], v160 offset:512
    s_waitcnt lgkmcnt(5)
    v_mfma_f32_32x32x16_bf16 v[24:39], v[68:71], v[72:75], v[24:39]
    v_mfma_f32_32x32x16_bf16 v[40:55], v[68:71], v[76:79], v[40:55]
    s_add_u32 m0, s60, 6144
    s_add_u32 s58, s58, 49152
    buffer_load_dwordx4 v153, s[32:35], s58 offen lds
    buffer_load_dwordx4 v154, s[32:35], s58 offen offset:1024 lds
    s_waitcnt vmcnt(4)
    ds_read_b128 v[68:71], v9 offset:16384
    ds_read_b64_tr_b16 v[72:73], v159 offset:2048
    ds_read_b64_tr_b16 v[74:75], v159 offset:2560
    ds_read_b64_tr_b16 v[76:77], v160 offset:2048
    ds_read_b64_tr_b16 v[78:79], v160 offset:2560
    s_waitcnt lgkmcnt(5)
    v_mfma_f32_32x32x16_bf16 v[24:39], v[56:59], v[60:63], v[24:39]
    v_mfma_f32_32x32x16_bf16 v[40:55], v[56:59], v[64:67], v[40:55]
    s_add_u32 m0, s60, 0
    s_xor_b32 s58, s69, 3
    s_mul_i32 s58, s58, 196608
    s_add_u32 s58, s58, s59
    buffer_load_dwordx4 v153, s[32:35], s58 offen lds
    buffer_load_dwordx4 v154, s[32:35], s58 offen offset:1024 lds
    s_waitcnt vmcnt(4)
    ds_read_b128 v[56:59], v8 offset:20480
    ds_read_b64_tr_b16 v[60:61], v159 offset:4096
    ds_read_b64_tr_b16 v[62:63], v159 offset:4608
    ds_read_b64_tr_b16 v[64:65], v160 offset:4096
    ds_read_b64_tr_b16 v[66:67], v160 offset:4608
    s_waitcnt lgkmcnt(5)
    v_mfma_f32_32x32x16_bf16 v[24:39], v[68:71], v[72:75], v[24:39]
    v_mfma_f32_32x32x16_bf16 v[40:55], v[68:71], v[76:79], v[40:55]
    s_add_u32 m0, s60, 2048
    s_add_u32 s58, s58, 49152
    buffer_load_dwordx4 v153, s[32:35], s58 offen lds
    buffer_load_dwordx4 v154, s[32:35], s58 offen offset:1024 lds
    s_waitcnt vmcnt(4)
    s_barrier
    ds_read_b128 v[68:71], v9 offset:20480
    ds_read_b64_tr_b16 v[72:73], v159 offset:6144
    ds_read_b64_tr_b16 v[74:75], v159 offset:6656
    ds_read_b64_tr_b16 v[76:77], v160 offset:6144
    ds_read_b64_tr_b16 v[78:79], v160 offset:6656
    s_waitcnt lgkmcnt(5)
    v_mfma_f32_32x32x16_bf16 v[24:39], v[56:59], v[60:63], v[24:39]
    v_mfma_f32_32x32x16_bf16 v[40:55], v[56:59], v[64:67], v[40:55]
    s_add_u32 m0, s60, 4096
    s_add_u32 s58, s58, 49152
    buffer_load_dwordx4 v153, s[32:35], s58 offen lds
    buffer_load_dwordx4 v154, s[32:35], s58 offen offset:1024 lds
    s_waitcnt vmcnt(4)
    ds_read_b128 v[56:59], v8 offset:24576
    ds_read_b64_tr_b16 v[60:61], v159 offset:0
    ds_read_b64_tr_b16 v[62:63], v159 offset:512
    ds_read_b64_tr_b16 v[64:65], v160 offset:0
    ds_read_b64_tr_b16 v[66:67], v160 offset:512
    s_waitcnt lgkmcnt(5)
    v_mfma_f32_32x32x16_bf16 v[24:39], v[68:71], v[72:75], v[24:39]
    v_mfma_f32_32x32x16_bf16 v[40:55], v[68:71], v[76:79], v[40:55]
    s_add_u32 m0, s60, 6144
    s_add_u32 s58, s58, 49152
    buffer_load_dwordx4 v153, s[32:35], s58 offen lds
    buffer_load_dwordx4 v154, s[32:35], s58 offen offset:1024 lds
    s_waitcnt vmcnt(4)
    ds_read_b128 v[68:71], v9 offset:24576
    ds_read_b64_tr_b16 v[72:73], v159 offset:2048
    ds_read_b64_tr_b16 v[74:75], v159 offset:2560
    ds_read_b64_tr_b16 v[76:77], v160 offset:2048
    ds_read_b64_tr_b16 v[78:79], v160 offset:2560
    s_waitcnt lgkmcnt(5)
    v_mfma_f32_32x32x16_bf16 v[24:39], v[56:59], v[60:63], v[24:39]
    v_mfma_f32_32x32x16_bf16 v[40:55], v[56:59], v[64:67], v[40:55]
    s_add_u32 m0, s60, 0
    s_xor_b32 s58, s69, 4
    s_mul_i32 s58, s58, 196608
    s_add_u32 s58, s58, s59
    buffer_load_dwordx4 v153, s[32:35], s58 offen lds
    buffer_load_dwordx4 v154, s[32:35], s58 offen offset:1024 lds
    s_waitcnt vmcnt(4)
    ds_read_b128 v[56:59], v8 offset:28672
    ds_read_b64_tr_b16 v[60:61], v159 offset:4096
    ds_read_b64_tr_b16 v[62:63], v159 offset:4608
    ds_read_b64_tr_b16 v[64:65], v160 offset:4096
    ds_read_b64_tr_b16 v[66:67], v160 offset:4608
    s_waitcnt lgkmcnt(5)
    v_mfma_f32_32x32x16_bf16 v[24:39], v[68:71], v[72:75], v[24:39]
    v_mfma_f32_32x32x16_bf16 v[40:55], v[68:71], v[76:79], v[40:55]
    s_add_u32 m0, s60, 2048
    s_add_u32 s58, s58, 49152
    buffer_load_dwordx4 v153, s[32:35], s58 offen lds
    buffer_load_dwordx4 v154, s[32:35], s58 offen offset:1024 lds
    s_waitcnt vmcnt(4)
    ds_read_b128 v[68:71], v9 offset:28672
    ds_read_b64_tr_b16 v[72:73], v159 offset:6144
    ds_read_b64_tr_b16 v[74:75], v159 offset:6656
    ds_read_b64_tr_b16 v[76:77], v160 offset:6144
    ds_read_b64_tr_b16 v[78:79], v160 offset:6656
    s_waitcnt lgkmcnt(5)
    v_mfma_f32_32x32x16_bf16 v[24:39], v[56:59], v[60:63], v[24:39]
    v_mfma_f32_32x32x16_bf16 v[40:55], v[56:59], v[64:67], v[40:55]
    s_add_u32 m0, s60, 4096
    s_add_u32 s58, s58, 49152
    buffer_load_dwordx4 v153, s[32:35], s58 offen lds
    buffer_load_dwordx4 v154, s[32:35], s58 offen offset:1024 lds
    s_waitcnt vmcnt(4)
    ds_read_b128 v[56:59], v8 offset:32768
    ds_read_b64_tr_b16 v[60:61], v159 offset:0
    ds_read_b64_tr_b16 v[62:63], v159 offset:512
    ds_read_b64_tr_b16 v[64:65], v160 offset:0
    ds_read_b64_tr_b16 v[66:67], v160 offset:512
    s_waitcnt lgkmcnt(5)
    v_mfma_f32_32x32x16_bf16 v[24:39], v[68:71], v[72:75], v[24:39]
    v_mfma_f32_32x32x16_bf16 v[40:55], v[68:71], v[76:79], v[40:55]
    s_add_u32 m0, s60, 6144
    s_add_u32 s58, s58, 49152
    buffer_load_dwordx4 v153, s[32:35], s58 offen lds
    buffer_load_dwordx4 v154, s[32:35], s58 offen offset:1024 lds
    s_waitcnt vmcnt(4)
    ds_read_b128 v[68:71], v9 offset:32768
    ds_read_b64_tr_b16 v[72:73], v159 offset:2048
    ds_read_b64_tr_b16 v[74:75], v159 offset:2560
    ds_read_b64_tr_b16 v[76:77], v160 offset:2048
    ds_read_b64_tr_b16 v[78:79], v160 offset:2560
    s_waitcnt lgkmcnt(5)
    v_mfma_f32_32x32x16_bf16 v[24:39], v[56:59], v[60:63], v[24:39]
    v_mfma_f32_32x32x16_bf16 v[40:55], v[56:59], v[64:67], v[40:55]
    s_add_u32 m0, s60, 0
    s_xor_b32 s58, s69, 5
    s_mul_i32 s58, s58, 196608
    s_add_u32 s58, s58, s59
    buffer_load_dwordx4 v153, s[32:35], s58 offen lds
    buffer_load_dwordx4 v154, s[32:35], s58 offen offset:1024 lds
    s_waitcnt vmcnt(4)
    ds_read_b128 v[56:59], v8 offset:36864
    ds_read_b64_tr_b16 v[60:61], v159 offset:4096
    ds_read_b64_tr_b16 v[62:63], v159 offset:4608
    ds_read_b64_tr_b16 v[64:65], v160 offset:4096
    ds_read_b64_tr_b16 v[66:67], v160 offset:4608
    s_waitcnt lgkmcnt(5)
    v_mfma_f32_32x32x16_bf16 v[24:39], v[68:71], v[72:75], v[24:39]
    v_mfma_f32_32x32x16_bf16 v[40:55], v[68:71], v[76:79], v[40:55]
    s_add_u32 m0, s60, 2048
    s_add_u32 s58, s58, 49152
    buffer_load_dwordx4 v153, s[32:35], s58 offen lds
    buffer_load_dwordx4 v154, s[32:35], s58 offen offset:1024 lds
    s_waitcnt vmcnt(4)
    ds_read_b128 v[68:71], v9 offset:36864
    ds_read_b64_tr_b16 v[72:73], v159 offset:6144
    ds_read_b64_tr_b16 v[74:75], v159 offset:6656
    ds_read_b64_tr_b16 v[76:77], v160 offset:6144
    ds_read_b64_tr_b16 v[78:79], v160 offset:6656
    s_waitcnt lgkmcnt(5)
    v_mfma_f32_32x32x16_bf16 v[24:39], v[56:59], v[60:63], v[24:39]
    v_mfma_f32_32x32x16_bf16 v[40:55], v[56:59], v[64:67], v[40:55]
    s_add_u32 m0, s60, 4096
    s_add_u32 s58, s58, 49152
    buffer_load_dwordx4 v153, s[32:35], s58 offen lds
    buffer_load_dwordx4 v154, s[32:35], s58 offen offset:1024 lds
    s_waitcnt vmcnt(4)
    ds_read_b128 v[56:59], v8 offset:40960
    ds_read_b64_tr_b16 v[60:61], v159 offset:0
    ds_read_b64_tr_b16 v[62:63], v159 offset:512
    ds_read_b64_tr_b16 v[64:65], v160 offset:0
    ds_read_b64_tr_b16 v[66:67], v160 offset:512
    s_waitcnt lgkmcnt(5)
    v_mfma_f32_32x32x16_bf16 v[24:39], v[68:71], v[72:75], v[24:39]
    v_mfma_f32_32x32x16_bf16 v[40:55], v[68:71], v[76:79], v[40:55]
    s_add_u32 m0, s60, 6144
    s_add_u32 s58, s58, 49152
    buffer_load_dwordx4 v153, s[32:35], s58 offen lds
    buffer_load_dwordx4 v154, s[32:35], s58 offen offset:1024 lds
    s_waitcnt vmcnt(4)
    ds_read_b128 v[68:71], v9 offset:40960
    ds_read_b64_tr_b16 v[72:73], v159 offset:2048
    ds_read_b64_tr_b16 v[74:75], v159 offset:2560
    ds_read_b64_tr_b16 v[76:77], v160 offset:2048
    ds_read_b64_tr_b16 v[78:79], v160 offset:2560
    s_waitcnt lgkmcnt(5)
    v_mfma_f32_32x32x16_bf16 v[24:39], v[56:59], v[60:63], v[24:39]
    v_mfma_f32_32x32x16_bf16 v[40:55], v[56:59], v[64:67], v[40:55]
    s_add_u32 m0, s60, 0
    s_xor_b32 s58, s69, 6
    s_mul_i32 s58, s58, 196608
    s_add_u32 s58, s58, s59
    buffer_load_dwordx4 v153, s[32:35], s58 offen lds
    buffer_load_dwordx4 v154, s[32:35], s58 offen offset:1024 lds
    s_waitcnt vmcnt(4)
    ds_read_b128 v[56:59], v8 offset:45056
    ds_read_b64_tr_b16 v[60:61], v159 offset:4096
    ds_read_b64_tr_b16 v[62:63], v159 offset:4608
    ds_read_b64_tr_b16 v[64:65], v160 offset:4096
    ds_read_b64_tr_b16 v[66:67], v160 offset:4608
    s_waitcnt lgkmcnt(5)
    v_mfma_f32_32x32x16_bf16 v[24:39], v[68:71], v[72:75], v[24:39]
    v_mfma_f32_32x32x16_bf16 v[40:55], v[68:71], v[76:79], v[40:55]
    s_add_u32 m0, s60, 2048
    s_add_u32 s58, s58, 49152
    buffer_load_dwordx4 v153, s[32:35], s58 offen lds
    buffer_load_dwordx4 v154, s[32:35], s58 offen offset:1024 lds
    s_waitcnt vmcnt(4)
    ds_read_b128 v[68:71], v9 offset:45056
    ds_read_b64_tr_b16 v[72:73], v159 offset:6144
    ds_read_b64_tr_b16 v[74:75], v159 offset:6656
    ds_read_b64_tr_b16 v[76:77], v160 offset:6144
    ds_read_b64_tr_b16 v[78:79], v160 offset:6656
    s_waitcnt lgkmcnt(5)
    v_mfma_f32_32x32x16_bf16 v[24:39], v[56:59], v[60:63], v[24:39]
    v_mfma_f32_32x32x16_bf16 v[40:55], v[56:59], v[64:67], v[40:55]
    s_add_u32 m0, s60, 4096
    s_add_u32 s58, s58, 49152
    buffer_load_dwordx4 v153, s[32:35], s58 offen lds
    buffer_load_dwordx4 v154, s[32:35], s58 offen offset:1024 lds
    s_waitcnt vmcnt(4)
    ds_read_b128 v[56:59], v8 offset:49152
    ds_read_b64_tr_b16 v[60:61], v159 offset:0
    ds_read_b64_tr_b16 v[62:63], v159 offset:512
    ds_read_b64_tr_b16 v[64:65], v160 offset:0
    ds_read_b64_tr_b16 v[66:67], v160 offset:512
    s_waitcnt lgkmcnt(5)
    v_mfma_f32_32x32x16_bf16 v[24:39], v[68:71], v[72:75], v[24:39]
    v_mfma_f32_32x32x16_bf16 v[40:55], v[68:71], v[76:79], v[40:55]
    s_add_u32 m0, s60, 6144
    s_add_u32 s58, s58, 49152
    buffer_load_dwordx4 v153, s[32:35], s58 offen lds
    buffer_load_dwordx4 v154, s[32:35], s58 offen offset:1024 lds
    s_waitcnt vmcnt(4)
    ds_read_b128 v[68:71], v9 offset:49152
    ds_read_b64_tr_b16 v[72:73], v159 offset:2048
    ds_read_b64_tr_b16 v[74:75], v159 offset:2560
    ds_read_b64_tr_b16 v[76:77], v160 offset:2048
    ds_read_b64_tr_b16 v[78:79], v160 offset:2560
    s_waitcnt lgkmcnt(5)
    v_mfma_f32_32x32x16_bf16 v[24:39], v[56:59], v[60:63], v[24:39]
    v_mfma_f32_32x32x16_bf16 v[40:55], v[56:59], v[64:67], v[40:55]
    s_add_u32 m0, s60, 0
    s_xor_b32 s58, s69, 7
    s_mul_i32 s58, s58, 196608
    s_add_u32 s58, s58, s59
    buffer_load_dwordx4 v153, s[32:35], s58 offen lds
    buffer_load_dwordx4 v154, s[32:35], s58 offen offset:1024 lds
    s_waitcnt vmcnt(4)
    ds_read_b128 v[56:59], v8 offset:53248
    ds_read_b64_tr_b16 v[60:61], v159 offset:4096
    ds_read_b64_tr_b16 v[62:63], v159 offset:4608
    ds_read_b64_tr_b16 v[64:65], v160 offset:4096
    ds_read_b64_tr_b16 v[66:67], v160 offset:4608
    s_waitcnt lgkmcnt(5)
    v_mfma_f32_32x32x16_bf16 v[24:39], v[68:71], v[72:75], v[24:39]
    v_mfma_f32_32x32x16_bf16 v[40:55], v[68:71], v[76:79], v[40:55]
    s_add_u32 m0, s60, 2048
    s_add_u32 s58, s58, 49152
    buffer_load_dwordx4 v153, s[32:35], s58 offen lds
    buffer_load_dwordx4 v154, s[32:35], s58 offen offset:1024 lds
    s_waitcnt vmcnt(4)
    ds_read_b128 v[68:71], v9 offset:53248
    ds_read_b64_tr_b16 v[72:73], v159 offset:6144
    ds_read_b64_tr_b16 v[74:75], v159 offset:6656
    ds_read_b64_tr_b16 v[76:77], v160 offset:6144
    ds_read_b64_tr_b16 v[78:79], v160 offset:6656
    s_waitcnt lgkmcnt(5)
    v_mfma_f32_32x32x16_bf16 v[24:39], v[56:59], v[60:63], v[24:39]
    v_mfma_f32_32x32x16_bf16 v[40:55], v[56:59], v[64:67], v[40:55]
    s_add_u32 m0, s60, 4096
    s_add_u32 s58, s58, 49152
    buffer_load_dwordx4 v153, s[32:35], s58 offen lds
    buffer_load_dwordx4 v154, s[32:35], s58 offen offset:1024 lds
    s_waitcnt vmcnt(4)
    ds_read_b128 v[56:59], v8 offset:57344
    ds_read_b64_tr_b16 v[60:61], v159 offset:0
    ds_read_b64_tr_b16 v[62:63], v159 offset:512
    ds_read_b64_tr_b16 v[64:65], v160 offset:0
    ds_read_b64_tr_b16 v[66:67], v160 offset:512
    s_waitcnt lgkmcnt(5)
    v_mfma_f32_32x32x16_bf16 v[24:39], v[68:71], v[72:75], v[24:39]
    v_mfma_f32_32x32x16_bf16 v[40:55], v[68:71], v[76:79], v[40:55]
    s_add_u32 m0, s60, 6144
    s_add_u32 s58, s58, 49152
    buffer_load_dwordx4 v153, s[32:35], s58 offen lds
    buffer_load_dwordx4 v154, s[32:35], s58 offen offset:1024 lds
    s_waitcnt vmcnt(4)
    ds_read_b128 v[68:71], v9 offset:57344
    ds_read_b64_tr_b16 v[72:73], v159 offset:2048
    ds_read_b64_tr_b16 v[74:75], v159 offset:2560
    ds_read_b64_tr_b16 v[76:77], v160 offset:2048
    ds_read_b64_tr_b16 v[78:79], v160 offset:2560
    s_waitcnt lgkmcnt(5)
    v_mfma_f32_32x32x16_bf16 v[24:39], v[56:59], v[60:63], v[24:39]
    v_mfma_f32_32x32x16_bf16 v[40:55], v[56:59], v[64:67], v[40:55]
    s_waitcnt vmcnt(2)
    ds_read_b128 v[56:59], v8 offset:61440
    ds_read_b64_tr_b16 v[60:61], v159 offset:4096
    ds_read_b64_tr_b16 v[62:63], v159 offset:4608
    ds_read_b64_tr_b16 v[64:65], v160 offset:4096
    ds_read_b64_tr_b16 v[66:67], v160 offset:4608
    s_waitcnt lgkmcnt(5)
    v_mfma_f32_32x32x16_bf16 v[24:39], v[68:71], v[72:75], v[24:39]
    v_mfma_f32_32x32x16_bf16 v[40:55], v[68:71], v[76:79], v[40:55]
    s_waitcnt vmcnt(0)
    ds_read_b128 v[68:71], v9 offset:61440
    ds_read_b64_tr_b16 v[72:73], v159 offset:6144
    ds_read_b64_tr_b16 v[74:75], v159 offset:6656
    ds_read_b64_tr_b16 v[76:77], v160 offset:6144
    ds_read_b64_tr_b16 v[78:79], v160 offset:6656
    s_waitcnt lgkmcnt(5)
    v_mfma_f32_32x32x16_bf16 v[24:39], v[56:59], v[60:63], v[24:39]
    v_mfma_f32_32x32x16_bf16 v[40:55], v[56:59], v[64:67], v[40:55]
    s_waitcnt lgkmcnt(0)
    v_mfma_f32_32x32x16_bf16 v[24:39], v[68:71], v[72:75], v[24:39]
    v_mfma_f32_32x32x16_bf16 v[40:55], v[68:71], v[76:79], v[40:55]
L_kvend:
    v_add_u32 v8, s60, v11
    s_nop 8
    s_cmp_lt_u32 s27, 2
    s_cbranch_scc1 L_kcvt
    v_pk_mul_f32 v[56:57], s[70:71], v[24:25]
    v_pk_mul_f32 v[58:59], s[70:71], v[26:27]
    v_pk_mul_f32 v[60:61], s[70:71], v[28:29]
    v_pk_mul_f32 v[62:63], s[70:71], v[30:31]
    v_pk_mul_f32 v[64:65], s[70:71], v[32:33]
    v_pk_mul_f32 v[66:67], s[70:71], v[34:35]
    v_pk_mul_f32 v[68:69], s[70:71], v[36:37]
    v_pk_mul_f32 v[70:71], s[70:71], v[38:39]
    v_pk_mul_f32 v[72:73], s[70:71], v[40:41]
    v_pk_mul_f32 v[74:75], s[70:71], v[42:43]
    v_pk_mul_f32 v[76:77], s[70:71], v[44:45]
    v_pk_mul_f32 v[78:79], s[70:71], v[46:47]
    v_pk_mul_f32 v[80:81], s[70:71], v[48:49]
    v_pk_mul_f32 v[82:83], s[70:71], v[50:51]
    v_pk_mul_f32 v[84:85], s[70:71], v[52:53]
    v_pk_mul_f32 v[86:87], s[70:71], v[54:55]
    v_exp_f32 v56, v56 clamp
    v_exp_f32 v57, v57 clamp
    v_exp_f32 v58, v58 clamp
    v_exp_f32 v59, v59 clamp
    v_exp_f32 v60, v60 clamp
    v_exp_f32 v61, v61 clamp
    v_exp_f32 v62, v62 clamp
    v_exp_f32 v63, v63 clamp
    v_exp_f32 v64, v64 clamp
    v_exp_f32 v65, v65 clamp
    v_exp_f32 v66, v66 clamp
    v_exp_f32 v67, v67 clamp
    v_exp_f32 v68, v68 clamp
    v_exp_f32 v69, v69 clamp
    v_exp_f32 v70, v70 clamp
    v_exp_f32 v71, v71 clamp
    v_exp_f32 v72, v72 clamp
    v_exp_f32 v73, v73 clamp
    v_exp_f32 v74, v74 clamp
    v_exp_f32 v75, v75 clamp
    v_exp_f32 v76, v76 clamp
    v_exp_f32 v77, v77 clamp
    v_exp_f32 v78, v78 clamp
    v_exp_f32 v79, v79 clamp
    v_exp_f32 v80, v80 clamp
    v_exp_f32 v81, v81 clamp
    v_exp_f32 v82, v82 clamp
    v_exp_f32 v83, v83 clamp
    v_exp_f32 v84, v84 clamp
    v_exp_f32 v85, v85 clamp
    v_exp_f32 v86, v86 clamp
    v_exp_f32 v87, v87 clamp
    v_max_f32 v24, s20, v24
    v_max_f32 v25, s20, v25
    v_max_f32 v26, s20, v26
    v_max_f32 v27, s20, v27
    v_max_f32 v28, s20, v28
    v_max_f32 v29, s20, v29
    v_max_f32 v30, s20, v30
    v_max_f32 v31, s20, v31
    v_max_f32 v32, s20, v32
    v_max_f32 v33, s20, v33
    v_max_f32 v34, s20, v34
    v_max_f32 v35, s20, v35
    v_max_f32 v36, s20, v36
    v_max_f32 v37, s20, v37
    v_max_f32 v38, s20, v38
    v_max_f32 v39, s20, v39
    v_max_f32 v40, s20, v40
    v_max_f32 v41, s20, v41
    v_max_f32 v42, s20, v42
    v_max_f32 v43, s20, v43
    v_max_f32 v44, s20, v44
    v_max_f32 v45, s20, v45
    v_max_f32 v46, s20, v46
    v_max_f32 v47, s20, v47
    v_max_f32 v48, s20, v48
    v_max_f32 v49, s20, v49
    v_max_f32 v50, s20, v50
    v_max_f32 v51, s20, v51
    v_max_f32 v52, s20, v52
    v_max_f32 v53, s20, v53
    v_max_f32 v54, s20, v54
    v_max_f32 v55, s20, v55
    v_pk_add_f32 v[24:25], v[24:25], v[56:57]
    v_pk_add_f32 v[26:27], v[26:27], v[58:59]
    v_pk_add_f32 v[28:29], v[28:29], v[60:61]
    v_pk_add_f32 v[30:31], v[30:31], v[62:63]
    v_pk_add_f32 v[32:33], v[32:33], v[64:65]
    v_pk_add_f32 v[34:35], v[34:35], v[66:67]
    v_pk_add_f32 v[36:37], v[36:37], v[68:69]
    v_pk_add_f32 v[38:39], v[38:39], v[70:71]
    v_pk_add_f32 v[40:41], v[40:41], v[72:73]
    v_pk_add_f32 v[42:43], v[42:43], v[74:75]
    v_pk_add_f32 v[44:45], v[44:45], v[76:77]
    v_pk_add_f32 v[46:47], v[46:47], v[78:79]
    v_pk_add_f32 v[48:49], v[48:49], v[80:81]
    v_pk_add_f32 v[50:51], v[50:51], v[82:83]
    v_pk_add_f32 v[52:53], v[52:53], v[84:85]
    v_pk_add_f32 v[54:55], v[54:55], v[86:87]
    s_cmp_eq_u32 s27, 2
    s_cselect_b32 s28, s80, s90
    s_cselect_b32 s29, s81, s91
    s_mov_b32 s30, 0x80000
    s_mov_b32 s31, 0x20000
    v_lshlrev_b32 v2, 7, v1
    s_lshl_b32 s53, s2, 11
    s_mov_b64 exec, 0xffff
    buffer_load_dword v157, v2, s[28:31], s53 offen
    s_mov_b64 exec, -1
L_kcvt:
    v_cvt_pk_bf16_f32 v56, v24, v25
    v_cvt_pk_bf16_f32 v57, v26, v27
    v_cvt_pk_bf16_f32 v58, v28, v29
    v_cvt_pk_bf16_f32 v59, v30, v31
    ds_write_b128 v8, v[56:59] offset:0
    v_cvt_pk_bf16_f32 v60, v32, v33
    v_cvt_pk_bf16_f32 v61, v34, v35
    v_cvt_pk_bf16_f32 v62, v36, v37
    v_cvt_pk_bf16_f32 v63, v38, v39
    ds_write_b128 v8, v[60:63] offset:1024
    v_cvt_pk_bf16_f32 v64, v40, v41
    v_cvt_pk_bf16_f32 v65, v42, v43
    v_cvt_pk_bf16_f32 v66, v44, v45
    v_cvt_pk_bf16_f32 v67, v46, v47
    ds_write_b128 v8, v[64:67] offset:2048
    v_cvt_pk_bf16_f32 v68, v48, v49
    v_cvt_pk_bf16_f32 v69, v50, v51
    v_cvt_pk_bf16_f32 v70, v52, v53
    v_cvt_pk_bf16_f32 v71, v54, v55
    ds_write_b128 v8, v[68:71] offset:3072
    v_add_u32 v2, s60, v156
    v_add_u32 v3, 131072, v156
    s_waitcnt lgkmcnt(0)
    ds_write_b32 v2, v158 offset:4096
    s_mov_b32 s62, 0
L_rdv:
    ds_read_b32 v72, v3 offset:4096
    ds_read_b32 v73, v3 offset:12288
    ds_read_b32 v74, v3 offset:20480
    ds_read_b32 v75, v3 offset:28672
    s_waitcnt lgkmcnt(0)
    v_min3_u32 v76, v72, v73, v74
    v_max3_u32 v77, v72, v73, v74
    v_min3_u32 v76, v76, v75, v158
    v_max3_u32 v77, v77, v75, v158
    v_cmp_ne_u32 vcc, v76, v77
    s_cbranch_vccz L_rdv_ok
    s_sleep 4
    s_add_u32 s62, s62, 1
    s_cmp_lt_u32 s62, 1000000
    s_cbranch_scc1 L_rdv
L_rdv_ok:
    s_cmp_lt_u32 s27, 2
    s_cbranch_scc1 L_a01b
    s_and_b32 s63, s2, 7
    s_lshl_b32 s63, s63, 3
    s_mul_i32 s53, s51, 16
    s_add_u32 s53, s53, 32
    s_add_u32 s55, s53, 16
L_kvdC:
    s_add_u32 s54, s53, s63
    s_and_b32 s54, s54, 63
    s_lshl_b32 s54, s54, 11
    s_add_u32 s54, s54, 131072
    s_lshl_b32 m0, s53, 11
    s_waitcnt vmcnt(40)
    buffer_load_dwordx4 v11, s[44:47], s54 offen offset:0 sc1 lds
    buffer_load_dwordx4 v11, s[44:47], s54 offen offset:1024 sc1 lds
    buffer_load_dwordx4 v11, s[44:47], s54 offen offset:2048 sc1 lds
    buffer_load_dwordx4 v11, s[44:47], s54 offen offset:3072 sc1 lds
    s_add_u32 m0, m0, 4096
    s_add_u32 s54, s54, 4096
    buffer_load_dwordx4 v11, s[44:47], s54 offen offset:0 sc1 lds
    buffer_load_dwordx4 v11, s[44:47], s54 offen offset:1024 sc1 lds
    buffer_load_dwordx4 v11, s[44:47], s54 offen offset:2048 sc1 lds
    buffer_load_dwordx4 v11, s[44:47], s54 offen offset:3072 sc1 lds
    s_add_u32 s53, s53, 4
    s_cmp_lt_u32 s53, s55
    s_cbranch_scc1 L_kvdC
    s_waitcnt vmcnt(0)
    s_endpgm
L_a01b:
    s_lshl_b32 s53, s27, 11
    s_add_u32 s53, s53, 131072
    v_add_u32 v3, s53, v11
    ds_read_b128 v[56:59], v3 offset:0
    ds_read_b128 v[72:75], v3 offset:16384
    ds_read_b128 v[60:63], v3 offset:1024
    ds_read_b128 v[76:79], v3 offset:17408
    ds_read_b128 v[64:67], v3 offset:8192
    ds_read_b128 v[80:83], v3 offset:24576
    ds_read_b128 v[68:71], v3 offset:9216
    ds_read_b128 v[84:87], v3 offset:25600
    v_mov_b32 v52, s21
    v_mov_b32 v53, s21
    v_mov_b32 v54, s21
    v_mov_b32 v55, s21
    v_bfe_u32 v4, v1, 3, 1
    v_lshlrev_b32 v4, 11, v4
    v_and_b32 v5, 3, v1
    v_lshl_add_u32 v4, v5, 9, v4
    v_bfe_u32 v5, v1, 4, 1
    v_lshl_add_u32 v4, v5, 3, v4
    v_bfe_u32 v5, v1, 2, 1
    v_lshl_add_u32 v4, v5, 2, v4
    s_waitcnt lgkmcnt(0)
    v_mfma_f32_32x32x16_bf16 v[16:31], v[72:75], v[56:59], 0
    v_mfma_f32_32x32x16_bf16 v[32:47], v[52:55], v[72:75], 0
    v_mfma_f32_32x32x16_bf16 v[16:31], v[76:79], v[60:63], v[16:31]
    v_mfma_f32_32x32x16_bf16 v[32:47], v[52:55], v[76:79], v[32:47]
    v_mfma_f32_32x32x16_bf16 v[16:31], v[80:83], v[64:67], v[16:31]
    v_mfma_f32_32x32x16_bf16 v[32:47], v[52:55], v[80:83], v[32:47]
    v_mfma_f32_32x32x16_bf16 v[16:31], v[84:87], v[68:71], v[16:31]
    v_mfma_f32_32x32x16_bf16 v[32:47], v[52:55], v[84:87], v[32:47]
    s_lshl_b32 s53, s23, 1
    s_add_u32 s53, s53, s27
    s_lshl_b32 s53, s53, 12
    s_add_u32 s53, s53, 262144
    s_nop 7
    v_cndmask_b32 v16, v24, v16, s[64:65]
    v_cndmask_b32 v17, v25, v17, s[64:65]
    v_cndmask_b32 v18, v26, v18, s[64:65]
    v_cndmask_b32 v19, v27, v19, s[64:65]
    v_cndmask_b32 v20, v28, v20, s[64:65]
    v_cndmask_b32 v21, v29, v21, s[64:65]
    v_cndmask_b32 v22, v30, v22, s[64:65]
    v_cndmask_b32 v23, v31, v23, s[64:65]
    buffer_atomic_add_f32 v16, v156, s[44:47], s53 offen offset:0 sc1
    buffer_atomic_add_f32 v17, v156, s[44:47], s53 offen offset:512 sc1
    buffer_atomic_add_f32 v18, v156, s[44:47], s53 offen offset:1024 sc1
    buffer_atomic_add_f32 v19, v156, s[44:47], s53 offen offset:1536 sc1
    buffer_atomic_add_f32 v20, v156, s[44:47], s53 offen offset:2048 sc1
    buffer_atomic_add_f32 v21, v156, s[44:47], s53 offen offset:2560 sc1
    buffer_atomic_add_f32 v22, v156, s[44:47], s53 offen offset:3072 sc1
    buffer_atomic_add_f32 v23, v156, s[44:47], s53 offen offset:3584 sc1
    s_mov_b32 exec_hi, 0
    buffer_atomic_add_f32 v32, v4, s[44:47], s53 offen offset:256 sc1
    s_mov_b32 exec_hi, -1
    s_lshl_b32 s56, s23, 8
    s_lshl_b32 s53, s49, 1
    s_add_u32 s53, s53, s27
    s_lshl_b32 s53, s53, 2
    s_add_u32 s53, s53, s56
    s_add_u32 s53, s53, 4096
    s_lshl_b32 s56, s3, 8
    s_add_u32 s56, s56, 4096
    s_waitcnt vmcnt(0)
    s_mov_b64 exec, 1
    buffer_store_dword v158, v156, s[44:47], s53 offen sc1
    s_mov_b64 exec, -1
    s_cmp_eq_u32 s27, 1
    s_cbranch_scc1 L_a1b
    s_barrier
    s_mov_b32 s62, 0
L_sfa:
    buffer_load_dword v157, v156, s[44:47], s56 offen sc1
    s_waitcnt vmcnt(0)
    v_cmp_ne_u32 vcc, v157, v158
    s_cbranch_vccz L_sfa_ok
    s_add_u32 s62, s62, 1
    s_cmp_lt_u32 s62, 100000
    s_cbranch_scc1 L_sfa
L_sfa_ok:
    s_barrier
    s_endpgm
L_a1b:
    s_mov_b32 s28, s80
    s_mov_b32 s29, s81
    s_mov_b32 s30, 0x80000
    s_mov_b32 s31, 0x20000
    s_mov_b32 s32, s90
    s_mov_b32 s33, s91
    s_mov_b32 s34, 0x80000
    s_mov_b32 s35, 0x20000
    s_and_b32 s5, s2, 7
    s_lshl_b32 s5, s5, 2
    s_bfe_u32 s54, s2, 0x20003
    s_add_u32 s5, s5, s54
    s_lshr_b32 s6, s2, 5
    v_lshrrev_b32 v2, 3, v1
    v_bfe_u32 v3, v1, 4, 1
    v_lshlrev_b32 v3, 2, v3
    v_xor_b32 v3, v3, v1
    v_and_b32 v3, 7, v3
    v_lshlrev_b32 v3, 4, v3
    v_mul_u32_u24 v2, 1024, v2
    v_add_u32 v7, v2, v3
    s_barrier
    s_lshl_b32 s53, s6, 7
    s_add_u32 s53, s53, 0
    s_mov_b32 m0, 0
L_woa:
    s_waitcnt vmcnt(40)
    buffer_load_dwordx4 v7, s[28:31], s53 offen lds
    s_add_u32 m0, m0, 1024
    s_add_u32 s53, s53, 8192
    buffer_load_dwordx4 v7, s[28:31], s53 offen lds
    s_add_u32 m0, m0, 1024
    s_add_u32 s53, s53, 8192
    buffer_load_dwordx4 v7, s[28:31], s53 offen lds
    s_add_u32 m0, m0, 1024
    s_add_u32 s53, s53, 8192
    buffer_load_dwordx4 v7, s[28:31], s53 offen lds
    s_add_u32 m0, m0, 1024
    s_add_u32 s53, s53, 8192
    s_cmp_lt_u32 m0, 65536
    s_cbranch_scc1 L_woa
    s_barrier
    s_lshl_b32 s53, s6, 7
    s_add_u32 s53, s53, 0
    s_mov_b32 m0, 131072
L_wob0:
    s_waitcnt vmcnt(40)
    buffer_load_dwordx4 v7, s[32:35], s53 offen lds
    s_add_u32 m0, m0, 1024
    s_add_u32 s53, s53, 8192
    buffer_load_dwordx4 v7, s[32:35], s53 offen lds
    s_add_u32 m0, m0, 1024
    s_add_u32 s53, s53, 8192
    buffer_load_dwordx4 v7, s[32:35], s53 offen lds
    s_add_u32 m0, m0, 1024
    s_add_u32 s53, s53, 8192
    buffer_load_dwordx4 v7, s[32:35], s53 offen lds
    s_add_u32 m0, m0, 1024
    s_add_u32 s53, s53, 8192
    s_cmp_lt_u32 m0, 163840
    s_cbranch_scc1 L_wob0
    s_waitcnt vmcnt(0)
    s_barrier
    s_lshl_b32 s53, s6, 7
    s_add_u32 s53, s53, 262144
    s_mov_b32 m0, 65536
L_wob1:
    s_waitcnt vmcnt(40)
    buffer_load_dwordx4 v7, s[32:35], s53 offen lds
    s_add_u32 m0, m0, 1024
    s_add_u32 s53, s53, 8192
    buffer_load_dwordx4 v7, s[32:35], s53 offen lds
    s_add_u32 m0, m0, 1024
    s_add_u32 s53, s53, 8192
    buffer_load_dwordx4 v7, s[32:35], s53 offen lds
    s_add_u32 m0, m0, 1024
    s_add_u32 s53, s53, 8192
    buffer_load_dwordx4 v7, s[32:35], s53 offen lds
    s_add_u32 m0, m0, 1024
    s_add_u32 s53, s53, 8192
    s_cmp_lt_u32 m0, 98304
    s_cbranch_scc1 L_wob1
    s_waitcnt vmcnt(0)
    s_endpgm
L_codeend:
.section .rodata,"a"
.p2align 6
.amdhsa_kernel gated_mix__linear_attn_block__grouped_kv_mqa__prompt_kernel
  .amdhsa_next_free_vgpr 168
  .amdhsa_next_free_sgpr 102
  .amdhsa_accum_offset 168
  .amdhsa_group_segment_fixed_size 0
  .amdhsa_kernarg_size 96
  .amdhsa_user_sgpr_count 2
  .amdhsa_user_sgpr_kernarg_segment_ptr 1
  .amdhsa_system_sgpr_workgroup_id_x 1
.end_amdhsa_kernel
```
